```python
import torch

def _softmax(x, axis=-1):
    return torch.softmax(x, dim=axis)

def _gelu(x):
    return torch.nn.functional.gelu(x, approximate='tanh')

def _silu(x):
    return torch.nn.functional.silu(x)

def _sigmoid(x):
    return torch.sigmoid(x)

def _layernorm(x, axis=-1, eps=1e-05):
    m = x.mean(dim=axis, keepdim=True)
    v = x.var(dim=axis, keepdim=True, unbiased=False)
    return (x - m) / torch.sqrt(v + eps)

def _scatter_add(tgt, idx, src, axis=0):
    return tgt.clone().index_add_(axis, idx, src)

def _segment_sum(src, seg, n):
    out = torch.zeros((n,) + src.shape[1:], dtype=src.dtype)
    return out.index_add_(0, seg, src)

def _pad(x, pw):
    flat = tuple((v for pair in reversed(pw) for v in pair))
    return torch.nn.functional.pad(x, flat)
kernel_name = 'adaLN_cond__compressed_kv_cla__glu_gated_glu__decode'

def setup_inputs():

    _w = lambda a: (lambda t: t.to(torch.bfloat16) if t.is_floating_point() else t)(torch.as_tensor(a))

    def _A_setup():
        B, H, Sq, Sk, D, M = (4, 32, 1, 4096, 128, 512)
        Dc = 4 * D
        return {'x': _w((lambda *s: torch.randn(*s, dtype=torch.bfloat16) * 0.05)(B, Sq, M)), 'c_kv': _w((lambda *s: torch.randn(*s, dtype=torch.bfloat16) * 1.6)(B, Sk, Dc)), 'w_q': _w((lambda *s: torch.randn(*s, dtype=torch.bfloat16) * 1.6)(M, H, D) * M ** (-0.5)), 'w_uk': _w((lambda *s: torch.randn(*s, dtype=torch.bfloat16) * 1.6)(Dc, H, D) * Dc ** (-0.5)), 'w_uv': _w((lambda *s: torch.randn(*s, dtype=torch.bfloat16) * 1.6)(Dc, H, D) * Dc ** (-0.5)), 'w_o': _w((lambda *s: torch.randn(*s, dtype=torch.bfloat16) * 1.6)(H, D, M) * (H * D) ** (-0.5))}
    _A_in = _A_setup()

    def _B_setup():
        B, S, D, F = (4, 1, 512, 1792)
        return {'x': _w((lambda *s: torch.randn(*s, dtype=torch.bfloat16) * 0.05)(B, S, D)), 'w_gate': _w((lambda *s: torch.randn(*s, dtype=torch.bfloat16) * 0.1)(D, F)), 'w_up': _w((lambda *s: torch.randn(*s, dtype=torch.bfloat16) * 0.05)(D, F)), 'w_down': _w((lambda *s: torch.randn(*s, dtype=torch.bfloat16) * 0.05)(F, D))}
    _B_in = _B_setup()
    return {'A_x': _A_in['x'], 'A_c_kv': _A_in['c_kv'], 'A_w_q': _A_in['w_q'], 'A_w_uk': _A_in['w_uk'], 'A_w_uv': _A_in['w_uv'], 'A_w_o': _A_in['w_o'], 'B_x': _B_in['x'], 'B_w_gate': _B_in['w_gate'], 'B_w_up': _B_in['w_up'], 'B_w_down': _B_in['w_down'], 'c': _w((lambda *s: torch.randn(*s, dtype=torch.bfloat16) * 0.2)(4, 512) * 8.0), 'w_mod': _w((lambda *s: torch.randn(*s, dtype=torch.bfloat16) * 0.2)(512, 6 * 512) * 512 ** (-0.5) * 8.0)}

def reference(A_x, A_c_kv, A_w_q, A_w_uk, A_w_uv, A_w_o, B_x, B_w_gate, B_w_up, B_w_down, c, w_mod):

    def _A_ref(x, c_kv, w_q, w_uk, w_uv, w_o):
        B, Sq, M = (x.shape[0], x.shape[1], x.shape[2])
        Sk = c_kv.shape[1]
        H, D = (w_q.shape[1], w_q.shape[2])
        q = torch.einsum('bqm,mhd->bhqd', x, w_q)
        k = torch.einsum('bkc,chd->bhkd', c_kv, w_uk)
        v = torch.einsum('bkc,chd->bhkd', c_kv, w_uv)
        scores = torch.einsum('bhqd,bhkd->bhqk', q, k) * D ** (-0.5)
        off = Sk - Sq
        qi = torch.arange(Sq)[:, None]
        kj = torch.arange(Sk)[None, :]
        cmask = kj <= qi + off
        scores = torch.where(cmask[None, None], scores, -1000000000.0)
        p = _softmax(scores, axis=-1)
        ctx = torch.einsum('bhqk,bhkd->bhqd', p, v)
        return torch.einsum('bhqd,hdm->bqm', ctx, w_o)

    def _B_ref(x, w_gate, w_up, w_down):
        g = torch.einsum('bsd,df->bsf', x, w_gate)
        u = torch.einsum('bsd,df->bsf', x, w_up)
        h = _sigmoid(g) * u
        return torch.einsum('bsf,fd->bsd', h, w_down)
    x = A_x
    mod = (_silu(c) @ w_mod).reshape(c.shape[0], 6, 1, -1)
    sa, ca, ga, sb, cb, gb = (mod[:, 0].clone(), mod[:, 1].clone(), mod[:, 2].clone(), mod[:, 3].clone(), mod[:, 4].clone(), mod[:, 5].clone())
    h = _layernorm(x, axis=-1) * (1 + ca) + sa
    x = x + ga * _A_ref(h, A_c_kv, A_w_q, A_w_uk, A_w_uv, A_w_o)
    h = _layernorm(x, axis=-1) * (1 + cb) + sb
    x = x + gb * _B_ref(h, B_w_gate, B_w_up, B_w_down)
    return x
```

```asm
; @launch grid=(256,1,1) block=(256,1,1) lds=163840
.amdgcn_target "amdgcn-amd-amdhsa--gfx950"
.text
.globl adaLN_cond__compressed_kv_cla__glu_gated_glu__decode_kernel
.p2align 8
.type adaLN_cond__compressed_kv_cla__glu_gated_glu__decode_kernel,@function
adaLN_cond__compressed_kv_cla__glu_gated_glu__decode_kernel:
    s_cmp_ge_u32 s2, 256
    s_cbranch_scc1 L_end
    s_load_dwordx16 s[4:19], s[0:1], 0
    s_load_dwordx8 s[20:27], s[0:1], 64
    s_load_dwordx2 s[28:29], s[0:1], 96
    s_load_dwordx2 s[30:31], s[0:1], 112
    s_getpc_b64 s[60:61]
L_pc:
    v_lshlrev_b32 v4, 7, v0
    s_mov_b32 s62, L_codeend-L_pc
    v_cmp_gt_u32 vcc, s62, v4
    s_nop 0
    s_and_saveexec_b64 s[62:63], vcc
    global_load_dword v5, v4, s[60:61]
    s_mov_b64 exec, -1
    v_lshrrev_b32 v4, 6, v0
    v_and_b32 v1, 63, v0
    v_readfirstlane_b32 s52, v4
    v_lshrrev_b32 v2, 4, v1
    v_and_b32 v3, 15, v1
    v_mov_b32 v4, 0
    s_and_b32 s53, s2, 7
    s_lshr_b32 s54, s2, 3
    s_lshl_b32 s60, s54, 2
    s_add_u32 s60, s60, s52
    s_lshl_b32 s60, s60, 2
    v_lshrrev_b32 v7, 1, v1
    v_add_u32 v7, s60, v7
    v_mul_u32_u24 v7, 6144, v7
    v_and_b32 v8, 1, v1
    v_lshl_add_u32 v7, v8, 10, v7
    s_lshl_b32 s60, s53, 7
    v_add_u32 v7, s60, v7
    s_cmp_ge_u32 s54, 16
    s_cbranch_scc1 L_A
L_F:
    s_lshl_b32 s60, s53, 2
    s_lshr_b32 s61, s54, 2
    s_add_u32 s56, s60, s61
    s_and_b32 s57, s54, 3
    s_lshl_b32 s61, s57, 7
    s_lshl_b32 s62, s52, 5
    s_add_u32 s58, s61, s62
    v_bfe_u32 v10, v1, 1, 2
    v_xor_b32 v10, v10, v2
    v_lshlrev_b32 v10, 5, v10
    v_and_b32 v11, 1, v1
    v_lshl_add_u32 v10, v11, 4, v10
    v_lshrrev_b32 v8, 3, v1
    v_lshl_add_u32 v8, v8, 13, v10
    s_lshl_b32 s60, s54, 2
    s_add_u32 s60, s60, s52
    s_lshl_b32 s60, s60, 16
    s_lshl_b32 s61, s53, 10
    s_add_u32 s60, s60, s61
    s_add_u32 s60, s60, 384
    v_lshlrev_b32 v63, 13, v1
    v_add_u32 v63, s60, v63
    v_lshrrev_b32 v16, 3, v1
    v_and_b32 v17, 2, v16
    v_and_b32 v18, 7, v1
    v_xor_b32 v17, v17, v18
    v_lshlrev_b32 v17, 4, v17
    v_lshl_add_u32 v16, v16, 13, v17
    v_xor_b32 v17, 64, v16
    s_lshl_b32 s67, s56, 8
    v_and_b32 v20, 3, v1
    v_lshlrev_b32 v21, 10, v20
    v_lshrrev_b32 v22, 2, v1
    v_lshl_add_u32 v21, v22, 4, v21
    s_lshl_b32 s60, s52, 8
    v_add_u32 v21, s60, v21
    s_waitcnt lgkmcnt(0)
    s_mov_b64 s[16:17], -1
    s_and_b32 exec_lo, s16, 0xff
    s_mov_b32 exec_hi, 0
    global_load_dword v5, v7, s[26:27]
    s_mov_b64 exec, s[16:17]
    s_mov_b32 s32, s30
    s_mov_b32 s33, s31
    s_mov_b32 s34, 268435456
    s_mov_b32 s35, 0x00020000
    buffer_load_dword v6, v4, s[32:35], 0 offen sc1
    s_mov_b32 s48, s4
    s_mov_b32 s49, s5
    s_mov_b32 s50, 4096
    s_mov_b32 s51, 0x00020000
    buffer_load_dwordx4 v[24:27], v21, s[48:51], 0 offen
    s_mov_b32 s40, s8
    s_mov_b32 s41, s9
    s_mov_b32 s42, 4194304
    s_mov_b32 s43, 0x00020000
    s_mov_b32 s36, s10
    s_mov_b32 s37, s11
    s_mov_b32 s38, 4194304
    s_mov_b32 s39, 0x00020000
    v_add_u32 v9, 128, v8
    s_and_b32 exec_lo, s16, 0xff
    s_mov_b32 exec_hi, 0
    global_load_dword v5, v63, s[8:9]
    global_load_dword v5, v63, s[10:11]
    s_mov_b64 exec, s[16:17]
    s_add_u32 s61, s57, 0
    s_and_b32 s61, s61, 3
    s_lshl_b32 s61, s61, 2
    s_add_u32 s61, s61, s52
    s_lshl_b32 s61, s61, 18
    s_add_u32 s61, s61, s67
    s_lshl_b32 s62, s52, 15
    s_add_u32 s62, s62, 0
    s_mov_b32 m0, s62
    s_add_u32 s62, s62, 1024
    buffer_load_dwordx4 v8, s[40:43], s61 offen  lds
    s_add_u32 s61, s61, 65536
    s_mov_b32 m0, s62
    s_add_u32 s62, s62, 1024
    buffer_load_dwordx4 v8, s[40:43], s61 offen  lds
    s_add_u32 s61, s61, 65536
    s_mov_b32 m0, s62
    s_add_u32 s62, s62, 1024
    buffer_load_dwordx4 v8, s[40:43], s61 offen  lds
    s_add_u32 s61, s61, 65536
    s_mov_b32 m0, s62
    s_add_u32 s62, s62, 1024
    buffer_load_dwordx4 v8, s[40:43], s61 offen  lds
    s_add_u32 s61, s61, 65536
    s_lshl_b32 s61, s58, 13
    s_add_u32 s61, s61, s67
    s_add_u32 s61, s61, 0
    s_lshl_b32 s62, s52, 13
    s_add_u32 s62, s62, 131072
    s_mov_b32 m0, s62
    s_add_u32 s62, s62, 1024
    buffer_load_dwordx4 v16, s[36:39], s61 offen nt lds
    s_add_u32 s61, s61, 65536
    s_mov_b32 m0, s62
    s_add_u32 s62, s62, 1024
    buffer_load_dwordx4 v16, s[36:39], s61 offen nt lds
    s_add_u32 s61, s61, 65536
    s_mov_b32 m0, s62
    s_add_u32 s62, s62, 1024
    buffer_load_dwordx4 v17, s[36:39], s61 offen nt lds
    s_add_u32 s61, s61, 65536
    s_mov_b32 m0, s62
    s_add_u32 s62, s62, 1024
    buffer_load_dwordx4 v17, s[36:39], s61 offen nt lds
    s_add_u32 s61, s61, 65536
    s_add_u32 s61, s57, 0
    s_and_b32 s61, s61, 3
    s_lshl_b32 s61, s61, 2
    s_add_u32 s61, s61, s52
    s_lshl_b32 s61, s61, 18
    s_add_u32 s61, s61, s67
    s_lshl_b32 s62, s52, 15
    s_add_u32 s62, s62, 4096
    s_mov_b32 m0, s62
    s_add_u32 s62, s62, 1024
    buffer_load_dwordx4 v9, s[40:43], s61 offen  lds
    s_add_u32 s61, s61, 65536
    s_mov_b32 m0, s62
    s_add_u32 s62, s62, 1024
    buffer_load_dwordx4 v9, s[40:43], s61 offen  lds
    s_add_u32 s61, s61, 65536
    s_mov_b32 m0, s62
    s_add_u32 s62, s62, 1024
    buffer_load_dwordx4 v9, s[40:43], s61 offen  lds
    s_add_u32 s61, s61, 65536
    s_mov_b32 m0, s62
    s_add_u32 s62, s62, 1024
    buffer_load_dwordx4 v9, s[40:43], s61 offen  lds
    s_add_u32 s61, s61, 65536
    s_lshl_b32 s61, s58, 13
    s_add_u32 s61, s61, s67
    s_add_u32 s61, s61, 128
    s_lshl_b32 s62, s52, 13
    s_add_u32 s62, s62, 135168
    s_mov_b32 m0, s62
    s_add_u32 s62, s62, 1024
    buffer_load_dwordx4 v16, s[36:39], s61 offen nt lds
    s_add_u32 s61, s61, 65536
    s_mov_b32 m0, s62
    s_add_u32 s62, s62, 1024
    buffer_load_dwordx4 v16, s[36:39], s61 offen nt lds
    s_add_u32 s61, s61, 65536
    s_mov_b32 m0, s62
    s_add_u32 s62, s62, 1024
    buffer_load_dwordx4 v17, s[36:39], s61 offen nt lds
    s_add_u32 s61, s61, 65536
    s_mov_b32 m0, s62
    s_add_u32 s62, s62, 1024
    buffer_load_dwordx4 v17, s[36:39], s61 offen nt lds
    s_add_u32 s61, s61, 65536
    s_add_u32 s61, s57, 1
    s_and_b32 s61, s61, 3
    s_lshl_b32 s61, s61, 2
    s_add_u32 s61, s61, s52
    s_lshl_b32 s61, s61, 18
    s_add_u32 s61, s61, s67
    s_lshl_b32 s62, s52, 15
    s_add_u32 s62, s62, 8192
    s_lshl_b32 s60, s52, 15
    s_add_u32 s60, s60, 24576
    v_lshl_add_u32 v21, v1, 4, s60
    v_lshlrev_b32 v20, 3, v20
    v_add_u32 v22, s60, v20
    v_add_u32 v20, 25600, v20
    v_add_u32 v23, 0x10000, v20
    v_lshrrev_b32 v28, 2, v3
    v_add_u32 v28, s57, v28
    v_and_b32 v28, 3, v28
    v_lshlrev_b32 v28, 15, v28
    v_lshrrev_b32 v29, 1, v2
    v_lshl_add_u32 v28, v29, 6, v28
    v_and_b32 v29, 3, v3
    v_lshl_add_u32 v28, v29, 4, v28
    v_and_b32 v29, 1, v2
    v_lshl_add_u32 v28, v29, 3, v28
    s_lshl_b32 s60, s52, 8
    s_add_u32 s60, s60, 24576
    v_add_u32 v28, s60, v28
    s_waitcnt vmcnt(18)
    ds_write_b128 v21, v[24:27]
    v_lshlrev_b32 v208, 16, v24
    v_and_b32 v209, 0xffff0000, v24
    v_lshlrev_b32 v210, 16, v25
    v_and_b32 v211, 0xffff0000, v25
    v_lshlrev_b32 v212, 16, v26
    v_and_b32 v213, 0xffff0000, v26
    v_lshlrev_b32 v214, 16, v27
    v_and_b32 v215, 0xffff0000, v27
    v_pk_add_f32 v[30:31], v[208:209], v[210:211]
    v_pk_add_f32 v[32:33], v[212:213], v[214:215]
    v_pk_add_f32 v[30:31], v[30:31], v[32:33]
    v_add_f32 v30, v30, v31
    s_nop 1
    v_add_f32_dpp v30, v30, v30 row_ror:4 row_mask:0xf bank_mask:0xf
    s_nop 1
    v_add_f32_dpp v30, v30, v30 row_ror:8 row_mask:0xf bank_mask:0xf
    v_mov_b32 v32, v30
    s_nop 1
    v_permlane16_swap_b32 v30, v32
    v_add_f32 v30, v30, v32
    v_mov_b32 v32, v30
    s_nop 1
    v_permlane32_swap_b32 v30, v32
    v_add_f32 v30, v30, v32
    v_mul_f32 v30, 0x3c000000, v30
    v_sub_f32 v208, v208, v30
    v_sub_f32 v209, v209, v30
    v_sub_f32 v210, v210, v30
    v_sub_f32 v211, v211, v30
    v_sub_f32 v212, v212, v30
    v_sub_f32 v213, v213, v30
    v_sub_f32 v214, v214, v30
    v_sub_f32 v215, v215, v30
    v_pk_mul_f32 v[32:33], v[208:209], v[208:209]
    v_pk_fma_f32 v[32:33], v[210:211], v[210:211], v[32:33]
    v_pk_fma_f32 v[32:33], v[212:213], v[212:213], v[32:33]
    v_pk_fma_f32 v[32:33], v[214:215], v[214:215], v[32:33]
    v_add_f32 v31, v32, v33
    s_nop 1
    v_add_f32_dpp v31, v31, v31 row_ror:4 row_mask:0xf bank_mask:0xf
    s_nop 1
    v_add_f32_dpp v31, v31, v31 row_ror:8 row_mask:0xf bank_mask:0xf
    v_mov_b32 v32, v31
    s_nop 1
    v_permlane16_swap_b32 v31, v32
    v_add_f32 v31, v31, v32
    v_mov_b32 v32, v31
    s_nop 1
    v_permlane32_swap_b32 v31, v32
    v_add_f32 v31, v31, v32
    ds_write_b64 v22, v[30:31] offset:1024
    s_waitcnt lgkmcnt(0)
    s_barrier
    ds_read_b64 v[32:33], v20 offset:0
    ds_read_b64 v[34:35], v20 offset:32768
    ds_read_b64 v[36:37], v23 offset:0
    ds_read_b64 v[38:39], v23 offset:32768
    ds_read_b64 v[24:25], v28
    ds_read_b64 v[26:27], v28 offset:128
    s_waitcnt lgkmcnt(0)
    v_add_f32 v30, v32, v34
    v_add_f32 v31, v36, v38
    v_add_f32 v30, v30, v31
    v_mul_f32 v30, 0.25, v30
    v_sub_f32 v32, v32, v30
    v_sub_f32 v34, v34, v30
    v_sub_f32 v36, v36, v30
    v_sub_f32 v38, v38, v30
    v_mul_f32 v31, v32, v32
    v_fmac_f32 v31, v34, v34
    v_fmac_f32 v31, v36, v36
    v_fmac_f32 v31, v38, v38
    v_add_f32 v33, v33, v35
    v_add_f32 v37, v37, v39
    v_add_f32 v33, v33, v37
    v_mul_f32 v31, 0.25, v31
    v_mov_b32 v32, 0x3b000000
    v_fmac_f32 v31, v33, v32
    v_cvt_pk_bf16_f32 v13, v30, v31
    v_lshlrev_b32 v30, 16, v13
    v_and_b32 v31, 0xffff0000, v13
    v_add_f32 v31, 0x3727c5ac, v31
    v_cvt_pk_bf16_f32 v13, v31, v31
    v_lshlrev_b32 v31, 16, v13
    v_sqrt_f32 v31, v31
    s_nop 0
    v_cvt_pk_bf16_f32 v13, v31, v31
    v_lshlrev_b32 v31, 16, v13
    v_rcp_f32 v31, v31
    v_lshlrev_b32 v208, 16, v24
    v_and_b32 v209, 0xffff0000, v24
    v_lshlrev_b32 v210, 16, v25
    v_and_b32 v211, 0xffff0000, v25
    v_lshlrev_b32 v212, 16, v26
    v_and_b32 v213, 0xffff0000, v26
    v_lshlrev_b32 v214, 16, v27
    v_and_b32 v215, 0xffff0000, v27
    v_sub_f32 v208, v208, v30
    v_sub_f32 v209, v209, v30
    v_sub_f32 v210, v210, v30
    v_sub_f32 v211, v211, v30
    v_sub_f32 v212, v212, v30
    v_sub_f32 v213, v213, v30
    v_sub_f32 v214, v214, v30
    v_sub_f32 v215, v215, v30
    v_cvt_pk_bf16_f32 v13, v208, v209
    v_lshlrev_b32 v208, 16, v13
    v_and_b32 v209, 0xffff0000, v13
    v_cvt_pk_bf16_f32 v13, v210, v211
    v_lshlrev_b32 v210, 16, v13
    v_and_b32 v211, 0xffff0000, v13
    v_cvt_pk_bf16_f32 v13, v212, v213
    v_lshlrev_b32 v212, 16, v13
    v_and_b32 v213, 0xffff0000, v13
    v_cvt_pk_bf16_f32 v13, v214, v215
    v_lshlrev_b32 v214, 16, v13
    v_and_b32 v215, 0xffff0000, v13
    v_mul_f32 v208, v208, v31
    v_mul_f32 v209, v209, v31
    v_mul_f32 v210, v210, v31
    v_mul_f32 v211, v211, v31
    v_mul_f32 v212, v212, v31
    v_mul_f32 v213, v213, v31
    v_mul_f32 v214, v214, v31
    v_mul_f32 v215, v215, v31
    v_cvt_pk_bf16_f32 v13, v208, v209
    v_lshlrev_b32 v208, 16, v13
    v_and_b32 v209, 0xffff0000, v13
    v_cvt_pk_bf16_f32 v13, v210, v211
    v_lshlrev_b32 v210, 16, v13
    v_and_b32 v211, 0xffff0000, v13
    v_cvt_pk_bf16_f32 v13, v212, v213
    v_lshlrev_b32 v212, 16, v13
    v_and_b32 v213, 0xffff0000, v13
    v_cvt_pk_bf16_f32 v13, v214, v215
    v_lshlrev_b32 v214, 16, v13
    v_and_b32 v215, 0xffff0000, v13
    s_mov_b32 m0, s62
    s_add_u32 s62, s62, 1024
    buffer_load_dwordx4 v8, s[40:43], s61 offen  lds
    s_add_u32 s61, s61, 65536
    s_mov_b32 m0, s62
    s_add_u32 s62, s62, 1024
    buffer_load_dwordx4 v8, s[40:43], s61 offen  lds
    s_add_u32 s61, s61, 65536
    s_mov_b32 m0, s62
    s_add_u32 s62, s62, 1024
    buffer_load_dwordx4 v8, s[40:43], s61 offen  lds
    s_add_u32 s61, s61, 65536
    s_mov_b32 m0, s62
    s_add_u32 s62, s62, 1024
    buffer_load_dwordx4 v8, s[40:43], s61 offen  lds
    s_add_u32 s61, s61, 65536
    s_add_u32 s61, s57, 1
    s_and_b32 s61, s61, 3
    s_lshl_b32 s61, s61, 2
    s_add_u32 s61, s61, s52
    s_lshl_b32 s61, s61, 18
    s_add_u32 s61, s61, s67
    s_lshl_b32 s62, s52, 15
    s_add_u32 s62, s62, 12288
    s_mov_b32 m0, s62
    s_add_u32 s62, s62, 1024
    buffer_load_dwordx4 v9, s[40:43], s61 offen  lds
    s_add_u32 s61, s61, 65536
    s_mov_b32 m0, s62
    s_add_u32 s62, s62, 1024
    buffer_load_dwordx4 v9, s[40:43], s61 offen  lds
    s_add_u32 s61, s61, 65536
    s_mov_b32 m0, s62
    s_add_u32 s62, s62, 1024
    buffer_load_dwordx4 v9, s[40:43], s61 offen  lds
    s_add_u32 s61, s61, 65536
    s_mov_b32 m0, s62
    s_add_u32 s62, s62, 1024
    buffer_load_dwordx4 v9, s[40:43], s61 offen  lds
    s_add_u32 s61, s61, 65536
    s_add_u32 s61, s57, 2
    s_and_b32 s61, s61, 3
    s_lshl_b32 s61, s61, 2
    s_add_u32 s61, s61, s52
    s_lshl_b32 s61, s61, 18
    s_add_u32 s61, s61, s67
    s_lshl_b32 s62, s52, 15
    s_add_u32 s62, s62, 16384
    s_mov_b32 m0, s62
    s_add_u32 s62, s62, 1024
    buffer_load_dwordx4 v8, s[40:43], s61 offen  lds
    s_add_u32 s61, s61, 65536
    s_mov_b32 m0, s62
    s_add_u32 s62, s62, 1024
    buffer_load_dwordx4 v8, s[40:43], s61 offen  lds
    s_add_u32 s61, s61, 65536
    s_mov_b32 m0, s62
    s_add_u32 s62, s62, 1024
    buffer_load_dwordx4 v8, s[40:43], s61 offen  lds
    s_add_u32 s61, s61, 65536
    s_mov_b32 m0, s62
    s_add_u32 s62, s62, 1024
    buffer_load_dwordx4 v8, s[40:43], s61 offen  lds
    s_add_u32 s61, s61, 65536
    s_add_u32 s61, s57, 2
    s_and_b32 s61, s61, 3
    s_lshl_b32 s61, s61, 2
    s_add_u32 s61, s61, s52
    s_lshl_b32 s61, s61, 18
    s_add_u32 s61, s61, s67
    s_lshl_b32 s62, s52, 15
    s_add_u32 s62, s62, 20480
    s_mov_b32 m0, s62
    s_add_u32 s62, s62, 1024
    buffer_load_dwordx4 v9, s[40:43], s61 offen  lds
    s_add_u32 s61, s61, 65536
    s_mov_b32 m0, s62
    s_add_u32 s62, s62, 1024
    buffer_load_dwordx4 v9, s[40:43], s61 offen  lds
    s_add_u32 s61, s61, 65536
    s_mov_b32 m0, s62
    s_add_u32 s62, s62, 1024
    buffer_load_dwordx4 v9, s[40:43], s61 offen  lds
    s_add_u32 s61, s61, 65536
    s_mov_b32 m0, s62
    s_add_u32 s62, s62, 1024
    buffer_load_dwordx4 v9, s[40:43], s61 offen  lds
    s_add_u32 s61, s61, 65536
    s_barrier
    s_add_u32 s61, s57, 3
    s_and_b32 s61, s61, 3
    s_lshl_b32 s61, s61, 2
    s_add_u32 s61, s61, s52
    s_lshl_b32 s61, s61, 18
    s_add_u32 s61, s61, s67
    s_lshl_b32 s62, s52, 15
    s_add_u32 s62, s62, 24576
    s_mov_b32 m0, s62
    s_add_u32 s62, s62, 1024
    buffer_load_dwordx4 v8, s[40:43], s61 offen  lds
    s_add_u32 s61, s61, 65536
    s_mov_b32 m0, s62
    s_add_u32 s62, s62, 1024
    buffer_load_dwordx4 v8, s[40:43], s61 offen  lds
    s_add_u32 s61, s61, 65536
    s_mov_b32 m0, s62
    s_add_u32 s62, s62, 1024
    buffer_load_dwordx4 v8, s[40:43], s61 offen  lds
    s_add_u32 s61, s61, 65536
    s_mov_b32 m0, s62
    s_add_u32 s62, s62, 1024
    buffer_load_dwordx4 v8, s[40:43], s61 offen  lds
    s_add_u32 s61, s61, 65536
    s_add_u32 s61, s57, 3
    s_and_b32 s61, s61, 3
    s_lshl_b32 s61, s61, 2
    s_add_u32 s61, s61, s52
    s_lshl_b32 s61, s61, 18
    s_add_u32 s61, s61, s67
    s_lshl_b32 s62, s52, 15
    s_add_u32 s62, s62, 28672
    s_mov_b32 m0, s62
    s_add_u32 s62, s62, 1024
    buffer_load_dwordx4 v9, s[40:43], s61 offen  lds
    s_add_u32 s61, s61, 65536
    s_mov_b32 m0, s62
    s_add_u32 s62, s62, 1024
    buffer_load_dwordx4 v9, s[40:43], s61 offen  lds
    s_add_u32 s61, s61, 65536
    s_mov_b32 m0, s62
    s_add_u32 s62, s62, 1024
    buffer_load_dwordx4 v9, s[40:43], s61 offen  lds
    s_add_u32 s61, s61, 65536
    s_mov_b32 m0, s62
    s_add_u32 s62, s62, 1024
    buffer_load_dwordx4 v9, s[40:43], s61 offen  lds
    s_add_u32 s61, s61, 65536
    v_lshrrev_b32 v12, 2, v3
    v_add_u32 v12, s57, v12
    v_and_b32 v12, 3, v12
    v_lshrrev_b32 v13, 1, v2
    v_lshl_add_u32 v12, v12, 4, v13
    v_lshlrev_b32 v12, 7, v12
    v_and_b32 v13, 3, v3
    v_lshl_add_u32 v12, v13, 5, v12
    v_and_b32 v13, 1, v2
    v_lshl_add_u32 v12, v13, 4, v12
    s_lshl_b32 s61, s52, 9
    s_add_u32 s64, s61, 131072
    s_lshl_b32 s61, s56, 2
    s_add_u32 s61, s61, s57
    s_lshl_b32 s59, s61, 5
    s_add_u32 s66, s64, 8192
    v_lshrrev_b32 v10, 2, v1
    v_bfe_u32 v11, v1, 3, 2
    v_lshlrev_b32 v10, 7, v10
    v_and_b32 v14, 3, v1
    v_lshl_add_u32 v10, v14, 3, v10
    s_lshl_b32 s61, s52, 15
    v_add_u32 v10, s61, v10
    v_xor_b32 v14, 0, v11
    v_lshl_add_u32 v56, v14, 5, v10
    v_xor_b32 v14, 1, v11
    v_lshl_add_u32 v57, v14, 5, v10
    v_xor_b32 v14, 2, v11
    v_lshl_add_u32 v58, v14, 5, v10
    v_xor_b32 v14, 3, v11
    v_lshl_add_u32 v59, v14, 5, v10
    v_lshrrev_b32 v13, 2, v3
    v_lshlrev_b32 v13, 3, v13
    v_and_b32 v14, 3, v3
    v_add_u32 v13, v13, v14
    v_and_b32 v14, 2, v13
    v_lshrrev_b32 v15, 2, v13
    v_and_b32 v15, 4, v15
    v_or_b32 v14, v14, v15
    v_xor_b32 v14, v14, v2
    v_lshlrev_b32 v13, 7, v13
    s_lshl_b32 s61, s52, 13
    s_add_u32 s61, s61, 131072
    v_add_u32 v13, s61, v13
    v_lshl_add_u32 v48, v14, 4, v13
    v_xor_b32 v49, 64, v48
    v_and_b32 v53, 3, v3
    v_lshlrev_b32 v53, 10, v53
    v_and_b32 v14, 1, v3
    v_lshl_add_u32 v53, v14, 4, v53
    v_bfe_u32 v14, v3, 1, 1
    v_lshl_add_u32 v53, v14, 6, v53
    v_lshl_add_u32 v52, v2, 4, v53
    s_lshl_b32 s61, s52, 15
    v_add_u32 v52, s61, v52
    v_lshrrev_b32 v14, 2, v3
    v_lshl_add_u32 v53, v14, 7, v53
    v_lshl_add_u32 v53, v2, 5, v53
    v_add_u32 v54, 0x10000, v53
    v_lshlrev_b32 v55, 15, v3
    v_lshl_add_u32 v55, v2, 4, v55
    s_lshl_b32 s61, s56, 10
    s_lshl_b32 s62, s58, 1
    s_add_u32 s65, s61, s62
    s_add_u32 s65, s65, 262144
    s_waitcnt vmcnt(24)
    v_readfirstlane_b32 s55, v6
    s_nop 0
    s_add_u32 s55, s55, 1
    ds_read_b128 v[16:19], v48 offset:0
    ds_read_b128 v[20:23], v49 offset:0
    ds_read_b128 v[24:27], v48 offset:4096
    ds_read_b128 v[28:31], v49 offset:4096
    ds_read_b128 v[32:35], v48 offset:512
    ds_read_b128 v[36:39], v49 offset:512
    ds_read_b128 v[40:43], v48 offset:4608
    ds_read_b128 v[44:47], v49 offset:4608
    ds_read_b64_tr_b16 a[0:1], v56 offset:0
    ds_read_b64_tr_b16 a[2:3], v56 offset:2048
    ds_read_b64_tr_b16 a[4:5], v57 offset:0
    ds_read_b64_tr_b16 a[6:7], v57 offset:2048
    ds_read_b64_tr_b16 a[8:9], v58 offset:0
    ds_read_b64_tr_b16 a[10:11], v58 offset:2048
    ds_read_b64_tr_b16 a[12:13], v59 offset:0
    ds_read_b64_tr_b16 a[14:15], v59 offset:2048
    ds_read_b64_tr_b16 a[16:17], v56 offset:4096
    ds_read_b64_tr_b16 a[18:19], v56 offset:6144
    ds_read_b64_tr_b16 a[20:21], v57 offset:4096
    ds_read_b64_tr_b16 a[22:23], v57 offset:6144
    ds_read_b64_tr_b16 a[24:25], v58 offset:4096
    ds_read_b64_tr_b16 a[26:27], v58 offset:6144
    ds_read_b64_tr_b16 a[28:29], v59 offset:4096
    ds_read_b64_tr_b16 a[30:31], v59 offset:6144
    s_waitcnt vmcnt(16)
    ds_read_b64_tr_b16 a[32:33], v56 offset:8192
    ds_read_b64_tr_b16 a[34:35], v56 offset:10240
    ds_read_b64_tr_b16 a[36:37], v57 offset:8192
    ds_read_b64_tr_b16 a[38:39], v57 offset:10240
    ds_read_b64_tr_b16 a[40:41], v58 offset:8192
    ds_read_b64_tr_b16 a[42:43], v58 offset:10240
    ds_read_b64_tr_b16 a[44:45], v59 offset:8192
    ds_read_b64_tr_b16 a[46:47], v59 offset:10240
    ds_read_b64_tr_b16 a[48:49], v56 offset:12288
    ds_read_b64_tr_b16 a[50:51], v56 offset:14336
    ds_read_b64_tr_b16 a[52:53], v57 offset:12288
    ds_read_b64_tr_b16 a[54:55], v57 offset:14336
    ds_read_b64_tr_b16 a[56:57], v58 offset:12288
    ds_read_b64_tr_b16 a[58:59], v58 offset:14336
    ds_read_b64_tr_b16 a[60:61], v59 offset:12288
    ds_read_b64_tr_b16 a[62:63], v59 offset:14336
    s_waitcnt vmcnt(8)
    ds_read_b64_tr_b16 a[64:65], v56 offset:16384
    ds_read_b64_tr_b16 a[66:67], v56 offset:18432
    ds_read_b64_tr_b16 a[68:69], v57 offset:16384
    ds_read_b64_tr_b16 a[70:71], v57 offset:18432
    ds_read_b64_tr_b16 a[72:73], v58 offset:16384
    ds_read_b64_tr_b16 a[74:75], v58 offset:18432
    ds_read_b64_tr_b16 a[76:77], v59 offset:16384
    ds_read_b64_tr_b16 a[78:79], v59 offset:18432
    ds_read_b64_tr_b16 a[80:81], v56 offset:20480
    ds_read_b64_tr_b16 a[82:83], v56 offset:22528
    ds_read_b64_tr_b16 a[84:85], v57 offset:20480
    ds_read_b64_tr_b16 a[86:87], v57 offset:22528
    ds_read_b64_tr_b16 a[88:89], v58 offset:20480
    ds_read_b64_tr_b16 a[90:91], v58 offset:22528
    ds_read_b64_tr_b16 a[92:93], v59 offset:20480
    ds_read_b64_tr_b16 a[94:95], v59 offset:22528
    s_waitcnt vmcnt(0)
    ds_read_b64_tr_b16 a[96:97], v56 offset:24576
    ds_read_b64_tr_b16 a[98:99], v56 offset:26624
    ds_read_b64_tr_b16 a[100:101], v57 offset:24576
    ds_read_b64_tr_b16 a[102:103], v57 offset:26624
    ds_read_b64_tr_b16 a[104:105], v58 offset:24576
    ds_read_b64_tr_b16 a[106:107], v58 offset:26624
    ds_read_b64_tr_b16 a[108:109], v59 offset:24576
    ds_read_b64_tr_b16 a[110:111], v59 offset:26624
    ds_read_b64_tr_b16 a[112:113], v56 offset:28672
    ds_read_b64_tr_b16 a[114:115], v56 offset:30720
    ds_read_b64_tr_b16 a[116:117], v57 offset:28672
    ds_read_b64_tr_b16 a[118:119], v57 offset:30720
    ds_read_b64_tr_b16 a[120:121], v58 offset:28672
    ds_read_b64_tr_b16 a[122:123], v58 offset:30720
    ds_read_b64_tr_b16 a[124:125], v59 offset:28672
    ds_read_b64_tr_b16 a[126:127], v59 offset:30720
    v_lshlrev_b32 v48, 8, v3
    v_lshl_add_u32 v48, v2, 4, v48
    s_lshl_b32 s61, s52, 6
    s_add_u32 s61, s61, 147456
    v_add_u32 v48, s61, v48
    v_lshlrev_b32 v49, 4, v1
    v_add_u32 v49, 147456, v49
    v_lshlrev_b32 v55, 15, v2
    v_lshl_add_u32 v55, v3, 4, v55
    s_lshl_b32 s61, s56, 10
    s_lshl_b32 s62, s57, 8
    s_add_u32 s65, s61, s62
    s_add_u32 s65, s65, 262144
    s_lshl_b32 s60, s53, 4
    s_add_u32 s60, s60, s54
    s_lshl_b32 s60, s60, 2
    s_add_u32 s60, s60, s52
    s_lshl_b32 s60, s60, 15
    s_add_u32 s60, s60, 24576
    v_lshlrev_b32 v62, 7, v1
    v_add_u32 v62, s60, v62
    v_add_u32 v63, 8192, v62
    s_mov_b32 s63, 0
Lp_1:
    buffer_load_dwordx4 v[128:131], v12, s[32:35], s64 offen sc1
    buffer_load_dwordx4 v[132:135], v12, s[32:35], s64 offen offset:256 sc1
    buffer_load_dwordx4 v[136:139], v12, s[32:35], s66 offen sc1
    buffer_load_dwordx4 v[140:143], v12, s[32:35], s66 offen offset:256 sc1
Lpc_3:
    s_waitcnt vmcnt(0)
    v_xor_b32 v13, s55, v129
    v_bitop3_b32 v13, v131, s55, v13 bitop3:0xbe
    v_bitop3_b32 v13, v133, s55, v13 bitop3:0xbe
    v_bitop3_b32 v13, v135, s55, v13 bitop3:0xbe
    v_bitop3_b32 v13, v137, s55, v13 bitop3:0xbe
    v_bitop3_b32 v13, v139, s55, v13 bitop3:0xbe
    v_bitop3_b32 v13, v141, s55, v13 bitop3:0xbe
    v_bitop3_b32 v13, v143, s55, v13 bitop3:0xbe
    v_cmp_ne_u32 vcc, 0, v13
    s_cbranch_vccz Lpd_2
    s_add_u32 s63, s63, 1
    s_cmp_lt_u32 s63, 30000
    s_cbranch_scc1 Lp_1
Lpd_2:
    global_load_dword v5, v62, s[6:7]
    v_lshlrev_b32 v144, 16, v136
    v_and_b32 v145, 0xffff0000, v136
    v_lshlrev_b32 v146, 16, v138
    v_and_b32 v147, 0xffff0000, v138
    v_lshlrev_b32 v148, 16, v140
    v_and_b32 v149, 0xffff0000, v140
    v_lshlrev_b32 v150, 16, v142
    v_and_b32 v151, 0xffff0000, v142
    v_pk_mul_f32 v[144:145], v[144:145], v[208:209]
    v_pk_mul_f32 v[146:147], v[146:147], v[210:211]
    v_pk_mul_f32 v[148:149], v[148:149], v[212:213]
    v_pk_mul_f32 v[150:151], v[150:151], v[214:215]
    v_cvt_pk_bf16_f32 v160, v144, v145
    v_cvt_pk_bf16_f32 v161, v146, v147
    v_cvt_pk_bf16_f32 v162, v148, v149
    v_cvt_pk_bf16_f32 v163, v150, v151
    v_lshlrev_b32 v152, 16, v128
    v_and_b32 v153, 0xffff0000, v128
    v_lshlrev_b32 v154, 16, v130
    v_and_b32 v155, 0xffff0000, v130
    v_lshlrev_b32 v156, 16, v132
    v_and_b32 v157, 0xffff0000, v132
    v_lshlrev_b32 v158, 16, v134
    v_and_b32 v159, 0xffff0000, v134
    v_lshlrev_b32 v144, 16, v160
    v_and_b32 v145, 0xffff0000, v160
    v_lshlrev_b32 v146, 16, v161
    v_and_b32 v147, 0xffff0000, v161
    v_lshlrev_b32 v148, 16, v162
    v_and_b32 v149, 0xffff0000, v162
    v_lshlrev_b32 v150, 16, v163
    v_and_b32 v151, 0xffff0000, v163
    v_pk_add_f32 v[144:145], v[144:145], v[152:153]
    v_pk_add_f32 v[146:147], v[146:147], v[154:155]
    v_pk_add_f32 v[148:149], v[148:149], v[156:157]
    v_pk_add_f32 v[150:151], v[150:151], v[158:159]
    v_cvt_pk_bf16_f32 v72, v144, v145
    v_cvt_pk_bf16_f32 v73, v146, v147
    v_cvt_pk_bf16_f32 v74, v148, v149
    v_cvt_pk_bf16_f32 v75, v150, v151
    s_waitcnt lgkmcnt(0)
    s_nop 0
    v_mfma_f32_16x16x32_bf16 v[96:99], a[0:3], v[72:75], 0
    v_mov_b32_dpp v76, v72 row_shl:4 row_mask:0xf bank_mask:0xf
    v_mfma_f32_16x16x32_bf16 v[100:103], a[4:7], v[72:75], 0
    v_mov_b32_dpp v77, v73 row_shl:4 row_mask:0xf bank_mask:0xf
    v_mfma_f32_16x16x32_bf16 v[104:107], a[8:11], v[72:75], 0
    v_mov_b32_dpp v78, v74 row_shl:4 row_mask:0xf bank_mask:0xf
    v_mfma_f32_16x16x32_bf16 v[108:111], a[12:15], v[72:75], 0
    v_mov_b32_dpp v79, v75 row_shl:4 row_mask:0xf bank_mask:0xf
    v_mfma_f32_16x16x32_bf16 v[112:115], a[16:19], v[72:75], 0
    v_mfma_f32_16x16x32_bf16 v[116:119], a[20:23], v[72:75], 0
    v_mfma_f32_16x16x32_bf16 v[120:123], a[24:27], v[72:75], 0
    v_mfma_f32_16x16x32_bf16 v[124:127], a[28:31], v[72:75], 0
    v_mfma_f32_16x16x32_bf16 v[96:99], a[32:35], v[76:79], v[96:99]
    v_mov_b32_dpp v80, v72 row_shl:8 row_mask:0xf bank_mask:0xf
    v_mfma_f32_16x16x32_bf16 v[100:103], a[36:39], v[76:79], v[100:103]
    v_mov_b32_dpp v81, v73 row_shl:8 row_mask:0xf bank_mask:0xf
    v_mfma_f32_16x16x32_bf16 v[104:107], a[40:43], v[76:79], v[104:107]
    v_mov_b32_dpp v82, v74 row_shl:8 row_mask:0xf bank_mask:0xf
    v_mfma_f32_16x16x32_bf16 v[108:111], a[44:47], v[76:79], v[108:111]
    v_mov_b32_dpp v83, v75 row_shl:8 row_mask:0xf bank_mask:0xf
    v_mfma_f32_16x16x32_bf16 v[112:115], a[48:51], v[76:79], v[112:115]
    v_mfma_f32_16x16x32_bf16 v[116:119], a[52:55], v[76:79], v[116:119]
    v_mfma_f32_16x16x32_bf16 v[120:123], a[56:59], v[76:79], v[120:123]
    v_mfma_f32_16x16x32_bf16 v[124:127], a[60:63], v[76:79], v[124:127]
    v_mfma_f32_16x16x32_bf16 v[96:99], a[64:67], v[80:83], v[96:99]
    v_mov_b32_dpp v84, v72 row_shl:12 row_mask:0xf bank_mask:0xf
    v_mfma_f32_16x16x32_bf16 v[100:103], a[68:71], v[80:83], v[100:103]
    v_mov_b32_dpp v85, v73 row_shl:12 row_mask:0xf bank_mask:0xf
    v_mfma_f32_16x16x32_bf16 v[104:107], a[72:75], v[80:83], v[104:107]
    v_mov_b32_dpp v86, v74 row_shl:12 row_mask:0xf bank_mask:0xf
    v_mfma_f32_16x16x32_bf16 v[108:111], a[76:79], v[80:83], v[108:111]
    v_mov_b32_dpp v87, v75 row_shl:12 row_mask:0xf bank_mask:0xf
    v_mfma_f32_16x16x32_bf16 v[112:115], a[80:83], v[80:83], v[112:115]
    v_mfma_f32_16x16x32_bf16 v[116:119], a[84:87], v[80:83], v[116:119]
    v_mfma_f32_16x16x32_bf16 v[120:123], a[88:91], v[80:83], v[120:123]
    v_mfma_f32_16x16x32_bf16 v[124:127], a[92:95], v[80:83], v[124:127]
    v_mfma_f32_16x16x32_bf16 v[96:99], a[96:99], v[84:87], v[96:99]
    v_mfma_f32_16x16x32_bf16 v[100:103], a[100:103], v[84:87], v[100:103]
    v_mfma_f32_16x16x32_bf16 v[104:107], a[104:107], v[84:87], v[104:107]
    v_mfma_f32_16x16x32_bf16 v[108:111], a[108:111], v[84:87], v[108:111]
    v_mfma_f32_16x16x32_bf16 v[112:115], a[112:115], v[84:87], v[112:115]
    v_mfma_f32_16x16x32_bf16 v[116:119], a[116:119], v[84:87], v[116:119]
    v_mfma_f32_16x16x32_bf16 v[120:123], a[120:123], v[84:87], v[120:123]
    v_mfma_f32_16x16x32_bf16 v[124:127], a[124:127], v[84:87], v[124:127]
    s_and_b32 exec_lo, s16, 0xf000f
    s_and_b32 exec_hi, s16, 0xf000f
    ds_write_b128 v52, v[96:99] offset:0
    ds_write_b128 v52, v[100:103] offset:64
    ds_write_b128 v52, v[104:107] offset:128
    ds_write_b128 v52, v[108:111] offset:192
    ds_write_b128 v52, v[112:115] offset:256
    ds_write_b128 v52, v[116:119] offset:320
    ds_write_b128 v52, v[120:123] offset:384
    ds_write_b128 v52, v[124:127] offset:448
    s_mov_b64 exec, s[16:17]
    s_waitcnt lgkmcnt(0)
    s_barrier
    ds_read_b128 v[96:99], v53 offset:0
    ds_read_b128 v[112:115], v53 offset:16
    ds_read_b128 v[100:103], v53 offset:32768
    ds_read_b128 v[116:119], v53 offset:32784
    ds_read_b128 v[104:107], v54 offset:0
    ds_read_b128 v[120:123], v54 offset:16
    ds_read_b128 v[108:111], v54 offset:32768
    ds_read_b128 v[124:127], v54 offset:32784
    s_waitcnt lgkmcnt(0)
    v_pk_add_f32 v[96:97], v[96:97], v[100:101]
    v_pk_add_f32 v[104:105], v[104:105], v[108:109]
    v_pk_add_f32 v[98:99], v[98:99], v[102:103]
    v_pk_add_f32 v[106:107], v[106:107], v[110:111]
    v_pk_add_f32 v[96:97], v[96:97], v[104:105]
    v_pk_add_f32 v[98:99], v[98:99], v[106:107]
    v_pk_add_f32 v[112:113], v[112:113], v[116:117]
    v_pk_add_f32 v[120:121], v[120:121], v[124:125]
    v_pk_add_f32 v[114:115], v[114:115], v[118:119]
    v_pk_add_f32 v[122:123], v[122:123], v[126:127]
    v_pk_add_f32 v[112:113], v[112:113], v[120:121]
    v_pk_add_f32 v[114:115], v[114:115], v[122:123]
    v_cvt_pk_bf16_f32 v72, v96, v97
    v_cvt_pk_bf16_f32 v73, v98, v99
    v_cvt_pk_bf16_f32 v74, v112, v113
    v_cvt_pk_bf16_f32 v75, v114, v115
    s_nop 1
    v_mfma_f32_16x16x32_bf16 v[96:99], v[16:19], v[72:75], 0
    v_mov_b32_dpp v76, v72 row_shl:4 row_mask:0xf bank_mask:0xf
    v_mov_b32_dpp v77, v73 row_shl:4 row_mask:0xf bank_mask:0xf
    v_mov_b32_dpp v78, v74 row_shl:4 row_mask:0xf bank_mask:0xf
    v_mov_b32_dpp v79, v75 row_shl:4 row_mask:0xf bank_mask:0xf
    v_mfma_f32_16x16x32_bf16 v[100:103], v[32:35], v[72:75], 0
    s_nop 0
    v_mfma_f32_16x16x32_bf16 v[96:99], v[20:23], v[76:79], v[96:99]
    v_mov_b32_dpp v80, v72 row_shl:8 row_mask:0xf bank_mask:0xf
    v_mov_b32_dpp v81, v73 row_shl:8 row_mask:0xf bank_mask:0xf
    v_mov_b32_dpp v82, v74 row_shl:8 row_mask:0xf bank_mask:0xf
    v_mov_b32_dpp v83, v75 row_shl:8 row_mask:0xf bank_mask:0xf
    v_mfma_f32_16x16x32_bf16 v[100:103], v[36:39], v[76:79], v[100:103]
    s_nop 0
    v_mfma_f32_16x16x32_bf16 v[96:99], v[24:27], v[80:83], v[96:99]
    v_mov_b32_dpp v84, v72 row_shl:12 row_mask:0xf bank_mask:0xf
    v_mov_b32_dpp v85, v73 row_shl:12 row_mask:0xf bank_mask:0xf
    v_mov_b32_dpp v86, v74 row_shl:12 row_mask:0xf bank_mask:0xf
    v_mov_b32_dpp v87, v75 row_shl:12 row_mask:0xf bank_mask:0xf
    v_mfma_f32_16x16x32_bf16 v[100:103], v[40:43], v[80:83], v[100:103]
    s_nop 0
    v_mfma_f32_16x16x32_bf16 v[96:99], v[28:31], v[84:87], v[96:99]
    v_mfma_f32_16x16x32_bf16 v[100:103], v[44:47], v[84:87], v[100:103]
    s_nop 6
    v_cvt_pk_bf16_f32 v128, v96, v97
    v_cvt_pk_bf16_f32 v129, v98, v99
    v_cvt_pk_bf16_f32 v130, v100, v101
    v_cvt_pk_bf16_f32 v131, v102, v103
    s_and_b32 exec_lo, s16, 0xf000f
    s_and_b32 exec_hi, s16, 0xf000f
    ds_write_b128 v48, v[128:131]
    s_mov_b64 exec, s[16:17]
    s_waitcnt lgkmcnt(0)
    s_barrier
    s_cmp_lg_u32 s52, 0
    s_cbranch_scc1 Lnq_4
    ds_read_b128 v[128:131], v49
    s_waitcnt lgkmcnt(0)
    buffer_store_dwordx4 v[128:131], v55, s[32:35], s65 offen sc1
Lnq_4:
    s_lshl_b32 s60, s54, 2
    s_add_u32 s60, s60, s52
    s_lshl_b32 s60, s60, 16
    s_lshl_b32 s61, s53, 10
    s_add_u32 s60, s60, s61
    s_add_u32 s60, s60, 384
    v_lshlrev_b32 v12, 13, v1
    v_add_u32 v12, s60, v12
    s_and_b32 exec_lo, s16, 0xff
    s_mov_b32 exec_hi, 0
    global_load_dword v5, v12, s[12:13]
    s_mov_b64 exec, s[16:17]
    s_mov_b32 s36, s12
    s_mov_b32 s37, s13
    s_mov_b32 s38, 4194304
    s_mov_b32 s39, 0x00020000
    s_mov_b32 s44, s26
    s_mov_b32 s45, s27
    s_mov_b32 s46, 3145728
    s_mov_b32 s47, 0x00020000
    s_mov_b32 s48, s24
    s_mov_b32 s49, s25
    s_mov_b32 s50, 4096
    s_mov_b32 s51, 0x00020000
    v_bfe_u32 v10, v1, 1, 2
    v_xor_b32 v10, v10, v2
    v_lshlrev_b32 v10, 5, v10
    v_and_b32 v11, 1, v1
    v_lshl_add_u32 v10, v11, 4, v10
    v_lshrrev_b32 v8, 5, v1
    v_lshlrev_b32 v8, 19, v8
    v_bfe_u32 v11, v1, 3, 2
    v_lshl_add_u32 v8, v11, 17, v8
    v_add_u32 v8, v8, v10
    v_add_u32 v9, 128, v8
    v_and_b32 v12, 3, v3
    v_lshlrev_b32 v12, 10, v12
    v_lshrrev_b32 v15, 2, v3
    v_lshl_add_u32 v12, v15, 6, v12
    v_lshl_add_u32 v12, v2, 4, v12
    s_lshl_b32 s60, s52, 8
    v_add_u32 v12, s60, v12
    buffer_load_dwordx4 v[192:195], v12, s[48:51], 0 offen
    v_lshrrev_b32 v12, 1, v1
    v_mul_u32_u24 v12, 6144, v12
    v_and_b32 v13, 1, v1
    v_lshl_add_u32 v12, v13, 4, v12
    s_add_u32 s63, s57, 0
    s_and_b32 s63, s63, 3
    s_lshl_b32 s62, s52, 2
    s_add_u32 s62, s62, s63
    s_mul_i32 s61, s62, 196608
    s_add_u32 s61, s61, s59
    s_add_u32 s61, s61, 2048
    s_lshl_b32 s62, s62, 10
    s_add_u32 m0, s62, 131072
    s_nop 0
    buffer_load_dwordx4 v12, s[44:47], s61 offen  lds
    s_add_u32 s63, s57, 1
    s_and_b32 s63, s63, 3
    s_lshl_b32 s62, s52, 2
    s_add_u32 s62, s62, s63
    s_mul_i32 s61, s62, 196608
    s_add_u32 s61, s61, s59
    s_add_u32 s61, s61, 2048
    s_lshl_b32 s62, s62, 10
    s_add_u32 m0, s62, 131072
    s_nop 0
    buffer_load_dwordx4 v12, s[44:47], s61 offen  lds
    s_add_u32 s63, s57, 2
    s_and_b32 s63, s63, 3
    s_lshl_b32 s62, s52, 2
    s_add_u32 s62, s62, s63
    s_mul_i32 s61, s62, 196608
    s_add_u32 s61, s61, s59
    s_add_u32 s61, s61, 2048
    s_lshl_b32 s62, s62, 10
    s_add_u32 m0, s62, 131072
    s_nop 0
    buffer_load_dwordx4 v12, s[44:47], s61 offen  lds
    s_add_u32 s63, s57, 3
    s_and_b32 s63, s63, 3
    s_lshl_b32 s62, s52, 2
    s_add_u32 s62, s62, s63
    s_mul_i32 s61, s62, 196608
    s_add_u32 s61, s61, s59
    s_add_u32 s61, s61, 2048
    s_lshl_b32 s62, s62, 10
    s_add_u32 m0, s62, 131072
    s_nop 0
    buffer_load_dwordx4 v12, s[44:47], s61 offen  lds
    s_add_u32 s63, s57, 0
    s_and_b32 s63, s63, 3
    s_lshl_b32 s63, s63, 5
    s_add_u32 s63, s63, s52
    s_lshl_b32 s63, s63, 15
    s_add_u32 s63, s63, s67
    s_lshl_b32 s62, s52, 13
    s_add_u32 s62, s62, 0
    s_mov_b32 s61, s63
    s_mov_b32 m0, s62
    s_add_u32 s62, s62, 1024
    buffer_load_dwordx4 v8, s[36:39], s61 offen  lds
    s_add_u32 s61, s61, 8192
    s_mov_b32 m0, s62
    s_add_u32 s62, s62, 1024
    buffer_load_dwordx4 v8, s[36:39], s61 offen  lds
    s_add_u32 s61, s61, 8192
    s_mov_b32 m0, s62
    s_add_u32 s62, s62, 1024
    buffer_load_dwordx4 v8, s[36:39], s61 offen  lds
    s_add_u32 s61, s61, 8192
    s_mov_b32 m0, s62
    s_add_u32 s62, s62, 1024
    buffer_load_dwordx4 v8, s[36:39], s61 offen  lds
    s_add_u32 s61, s61, 8192
    s_mov_b32 s61, s63
    s_mov_b32 m0, s62
    s_add_u32 s62, s62, 1024
    buffer_load_dwordx4 v9, s[36:39], s61 offen  lds
    s_add_u32 s61, s61, 8192
    s_mov_b32 m0, s62
    s_add_u32 s62, s62, 1024
    buffer_load_dwordx4 v9, s[36:39], s61 offen  lds
    s_add_u32 s61, s61, 8192
    s_mov_b32 m0, s62
    s_add_u32 s62, s62, 1024
    buffer_load_dwordx4 v9, s[36:39], s61 offen  lds
    s_add_u32 s61, s61, 8192
    s_mov_b32 m0, s62
    s_add_u32 s62, s62, 1024
    buffer_load_dwordx4 v9, s[36:39], s61 offen  lds
    s_add_u32 s61, s61, 8192
    s_add_u32 s63, s57, 1
    s_and_b32 s63, s63, 3
    s_lshl_b32 s63, s63, 5
    s_add_u32 s63, s63, s52
    s_lshl_b32 s63, s63, 15
    s_add_u32 s63, s63, s67
    s_lshl_b32 s62, s52, 13
    s_add_u32 s62, s62, 32768
    s_mov_b32 s61, s63
    s_mov_b32 m0, s62
    s_add_u32 s62, s62, 1024
    buffer_load_dwordx4 v8, s[36:39], s61 offen  lds
    s_add_u32 s61, s61, 8192
    s_mov_b32 m0, s62
    s_add_u32 s62, s62, 1024
    buffer_load_dwordx4 v8, s[36:39], s61 offen  lds
    s_add_u32 s61, s61, 8192
    s_mov_b32 m0, s62
    s_add_u32 s62, s62, 1024
    buffer_load_dwordx4 v8, s[36:39], s61 offen  lds
    s_add_u32 s61, s61, 8192
    s_mov_b32 m0, s62
    s_add_u32 s62, s62, 1024
    buffer_load_dwordx4 v8, s[36:39], s61 offen  lds
    s_add_u32 s61, s61, 8192
    s_mov_b32 s61, s63
    s_mov_b32 m0, s62
    s_add_u32 s62, s62, 1024
    buffer_load_dwordx4 v9, s[36:39], s61 offen  lds
    s_add_u32 s61, s61, 8192
    s_mov_b32 m0, s62
    s_add_u32 s62, s62, 1024
    buffer_load_dwordx4 v9, s[36:39], s61 offen  lds
    s_add_u32 s61, s61, 8192
    s_mov_b32 m0, s62
    s_add_u32 s62, s62, 1024
    buffer_load_dwordx4 v9, s[36:39], s61 offen  lds
    s_add_u32 s61, s61, 8192
    s_mov_b32 m0, s62
    s_add_u32 s62, s62, 1024
    buffer_load_dwordx4 v9, s[36:39], s61 offen  lds
    s_add_u32 s61, s61, 8192
    v_lshrrev_b32 v10, 2, v1
    v_bfe_u32 v11, v1, 3, 2
    v_lshlrev_b32 v10, 7, v10
    v_and_b32 v14, 3, v1
    v_lshl_add_u32 v10, v14, 3, v10
    v_and_b32 v12, 3, v1
    v_lshlrev_b32 v13, 3, v12
    v_sub_u32 v10, v10, v13
    v_lshrrev_b32 v13, 1, v12
    s_and_b32 s61, s52, 1
    s_lshl_b32 s61, s61, 1
    v_add_u32 v13, s61, v13
    v_xor_b32 v13, v13, v11
    v_lshl_add_u32 v10, v13, 5, v10
    v_and_b32 v12, 1, v12
    v_lshl_add_u32 v10, v12, 4, v10
    s_lshr_b32 s61, s52, 1
    s_lshl_b32 s61, s61, 12
    v_add_u32 v10, s61, v10
    v_add_u32 v11, 0x10000, v10
    v_and_b32 v13, 7, v3
    v_lshrrev_b32 v14, 1, v13
    v_and_b32 v13, 1, v13
    v_mov_b32 v15, 0xffff
    v_lshlrev_b32 v13, 4, v13
    v_lshlrev_b32 v15, v13, v15
    v_cmp_eq_u32 vcc, 0, v14
    s_nop 1
    v_cndmask_b32 v16, 0, v15, vcc
    v_cmp_eq_u32 vcc, 1, v14
    s_nop 1
    v_cndmask_b32 v17, 0, v15, vcc
    v_cmp_eq_u32 vcc, 2, v14
    s_nop 1
    v_cndmask_b32 v18, 0, v15, vcc
    v_cmp_eq_u32 vcc, 3, v14
    s_nop 1
    v_cndmask_b32 v19, 0, v15, vcc
    v_mov_b32 v13, 0x01000100
    v_mov_b32 v14, 0x03020302
    v_cmp_gt_u32 vcc, 8, v3
    s_nop 1
    v_cndmask_b32 v20, v14, v13, vcc
    v_and_b32 v21, 31, v1
    v_lshlrev_b32 v22, 9, v21
    s_lshl_b32 s61, s57, 14
    s_lshl_b32 s62, s56, 4
    s_add_u32 s64, s61, s62
    s_add_u32 s64, s64, 16384
    s_add_u32 s66, s64, 8
    s_andn2_b32 s66, s66, 256
    v_lshlrev_b32 v23, 10, v2
    v_lshl_add_u32 v23, v3, 4, v23
    s_lshl_b32 s61, s57, 5
    s_add_u32 s61, s61, s56
    s_lshl_b32 s61, s61, 15
    s_lshl_b32 s62, s52, 8
    s_add_u32 s65, s61, s62
    s_add_u32 s65, s65, 1048576
    v_and_b32 v24, 3, v21
    v_lshlrev_b32 v24, 5, v24
    v_lshrrev_b32 v25, 2, v21
    v_lshl_add_u32 v24, v25, 2, v24
    s_lshl_b32 s61, s52, 8
    s_add_u32 s61, s61, 156672
    v_add_u32 v24, s61, v24
    v_lshlrev_b32 v25, 5, v2
    v_add_u32 v25, s61, v25
    v_lshlrev_b32 v56, 4, v2
    v_add_u32 v27, 159744, v56
    v_and_b32 v13, 1, v3
    v_lshlrev_b32 v13, 5, v13
    v_bfe_u32 v14, v3, 1, 1
    v_lshl_add_u32 v13, v14, 3, v13
    v_lshrrev_b32 v14, 2, v3
    v_lshl_add_u32 v13, v14, 6, v13
    v_and_b32 v14, 1, v2
    v_lshl_add_u32 v13, v14, 4, v13
    s_sub_u32 s61, s52, s57
    s_and_b32 s61, s61, 3
    s_lshl_b32 s61, s61, 8
    s_add_u32 s61, s61, 159744
    v_add_u32 v26, s61, v13
    s_lshl_b32 s61, s57, 13
    s_add_u32 s61, s61, s67
    s_lshl_b32 s62, s52, 6
    s_add_u32 s61, s61, s62
    s_add_u32 s58, s61, 393216
    v_bfe_u32 v57, v1, 2, 2
    v_lshlrev_b32 v57, 5, v57
    v_lshl_add_u32 v57, v2, 8, v57
    v_and_b32 v14, 3, v1
    v_lshl_add_u32 v57, v14, 3, v57
    s_lshl_b32 s60, s52, 12
    s_add_u32 s60, s60, 131072
    v_add_u32 v57, s60, v57
    v_lshlrev_b32 v59, 6, v3
    v_lshl_add_u32 v59, v2, 4, v59
    v_add_u32 v60, 155648, v59
    s_lshl_b32 s61, s52, 8
    v_add_u32 v59, s61, v60
    s_waitcnt vmcnt(20)
    v_lshlrev_b32 v96, 16, v192
    v_and_b32 v97, 0xffff0000, v192
    v_lshlrev_b32 v98, 16, v193
    v_and_b32 v99, 0xffff0000, v193
    v_lshlrev_b32 v100, 16, v194
    v_and_b32 v101, 0xffff0000, v194
    v_lshlrev_b32 v102, 16, v195
    v_and_b32 v103, 0xffff0000, v195
    s_mov_b32 s60, 0xbfb8aa3b
    v_mul_f32 v104, s60, v96
    v_mul_f32 v105, s60, v97
    v_mul_f32 v106, s60, v98
    v_mul_f32 v107, s60, v99
    v_mul_f32 v108, s60, v100
    v_mul_f32 v109, s60, v101
    v_mul_f32 v110, s60, v102
    v_mul_f32 v111, s60, v103
    v_exp_f32 v104, v104
    v_exp_f32 v105, v105
    v_exp_f32 v106, v106
    v_exp_f32 v107, v107
    v_exp_f32 v108, v108
    v_exp_f32 v109, v109
    v_exp_f32 v110, v110
    v_exp_f32 v111, v111
    v_add_f32 v104, 1.0, v104
    v_add_f32 v105, 1.0, v105
    v_add_f32 v106, 1.0, v106
    v_add_f32 v107, 1.0, v107
    v_add_f32 v108, 1.0, v108
    v_add_f32 v109, 1.0, v109
    v_add_f32 v110, 1.0, v110
    v_add_f32 v111, 1.0, v111
    v_rcp_f32 v104, v104
    v_rcp_f32 v105, v105
    v_rcp_f32 v106, v106
    v_rcp_f32 v107, v107
    v_rcp_f32 v108, v108
    v_rcp_f32 v109, v109
    v_rcp_f32 v110, v110
    v_rcp_f32 v111, v111
    v_pk_mul_f32 v[96:97], v[96:97], v[104:105]
    v_pk_mul_f32 v[98:99], v[98:99], v[106:107]
    v_pk_mul_f32 v[100:101], v[100:101], v[108:109]
    v_pk_mul_f32 v[102:103], v[102:103], v[110:111]
    v_cvt_pk_bf16_f32 v192, v96, v97
    v_cvt_pk_bf16_f32 v193, v98, v99
    v_cvt_pk_bf16_f32 v194, v100, v101
    v_cvt_pk_bf16_f32 v195, v102, v103
    v_mov_b32_dpp v196, v192 row_shl:4 row_mask:0xf bank_mask:0xf
    v_mov_b32_dpp v197, v193 row_shl:4 row_mask:0xf bank_mask:0xf
    v_mov_b32_dpp v198, v194 row_shl:4 row_mask:0xf bank_mask:0xf
    v_mov_b32_dpp v199, v195 row_shl:4 row_mask:0xf bank_mask:0xf
    v_mov_b32_dpp v200, v192 row_shl:8 row_mask:0xf bank_mask:0xf
    v_mov_b32_dpp v201, v193 row_shl:8 row_mask:0xf bank_mask:0xf
    v_mov_b32_dpp v202, v194 row_shl:8 row_mask:0xf bank_mask:0xf
    v_mov_b32_dpp v203, v195 row_shl:8 row_mask:0xf bank_mask:0xf
    v_mov_b32_dpp v204, v192 row_shl:12 row_mask:0xf bank_mask:0xf
    v_mov_b32_dpp v205, v193 row_shl:12 row_mask:0xf bank_mask:0xf
    v_mov_b32_dpp v206, v194 row_shl:12 row_mask:0xf bank_mask:0xf
    v_mov_b32_dpp v207, v195 row_shl:12 row_mask:0xf bank_mask:0xf
    s_waitcnt vmcnt(16)
    ds_read_b64_tr_b16 v[96:97], v57 offset:0
    ds_read_b64_tr_b16 v[98:99], v57 offset:128
    ds_read_b64_tr_b16 v[100:101], v57 offset:1024
    ds_read_b64_tr_b16 v[102:103], v57 offset:1152
    ds_read_b64_tr_b16 v[104:105], v57 offset:2048
    ds_read_b64_tr_b16 v[106:107], v57 offset:2176
    ds_read_b64_tr_b16 v[108:109], v57 offset:3072
    ds_read_b64_tr_b16 v[110:111], v57 offset:3200
    s_waitcnt lgkmcnt(6)
    v_mfma_f32_16x16x32_bf16 v[64:67], v[96:99], v[192:195], 0
    s_waitcnt lgkmcnt(4)
    v_mfma_f32_16x16x32_bf16 v[64:67], v[100:103], v[196:199], v[64:67]
    s_waitcnt lgkmcnt(2)
    v_mfma_f32_16x16x32_bf16 v[64:67], v[104:107], v[200:203], v[64:67]
    s_waitcnt lgkmcnt(0)
    v_mfma_f32_16x16x32_bf16 v[64:67], v[108:111], v[204:207], v[64:67]
    s_and_b32 exec_lo, s16, 0xf000f
    s_and_b32 exec_hi, s16, 0xf000f
    s_nop 5
    ds_write_b128 v59, v[64:67]
    s_mov_b64 exec, s[16:17]
    s_add_u32 s63, s57, 2
    s_and_b32 s63, s63, 3
    s_lshl_b32 s63, s63, 5
    s_add_u32 s63, s63, s52
    s_lshl_b32 s63, s63, 15
    s_add_u32 s63, s63, s67
    s_lshl_b32 s62, s52, 13
    s_add_u32 s62, s62, 65536
    s_mov_b32 s61, s63
    s_mov_b32 m0, s62
    s_add_u32 s62, s62, 1024
    buffer_load_dwordx4 v8, s[36:39], s61 offen  lds
    s_add_u32 s61, s61, 8192
    s_mov_b32 m0, s62
    s_add_u32 s62, s62, 1024
    buffer_load_dwordx4 v8, s[36:39], s61 offen  lds
    s_add_u32 s61, s61, 8192
    s_mov_b32 m0, s62
    s_add_u32 s62, s62, 1024
    buffer_load_dwordx4 v8, s[36:39], s61 offen  lds
    s_add_u32 s61, s61, 8192
    s_mov_b32 m0, s62
    s_add_u32 s62, s62, 1024
    buffer_load_dwordx4 v8, s[36:39], s61 offen  lds
    s_add_u32 s61, s61, 8192
    s_mov_b32 s61, s63
    s_mov_b32 m0, s62
    s_add_u32 s62, s62, 1024
    buffer_load_dwordx4 v9, s[36:39], s61 offen  lds
    s_add_u32 s61, s61, 8192
    s_mov_b32 m0, s62
    s_add_u32 s62, s62, 1024
    buffer_load_dwordx4 v9, s[36:39], s61 offen  lds
    s_add_u32 s61, s61, 8192
    s_mov_b32 m0, s62
    s_add_u32 s62, s62, 1024
    buffer_load_dwordx4 v9, s[36:39], s61 offen  lds
    s_add_u32 s61, s61, 8192
    s_mov_b32 m0, s62
    s_add_u32 s62, s62, 1024
    buffer_load_dwordx4 v9, s[36:39], s61 offen  lds
    s_add_u32 s61, s61, 8192
    s_waitcnt vmcnt(16) lgkmcnt(0)
    s_barrier
    s_cmp_lg_u32 s52, 0
    s_cbranch_scc1 Llm_6
    ds_read_b128 v[96:99], v60 offset:0
    ds_read_b128 v[100:103], v60 offset:256
    ds_read_b128 v[104:107], v60 offset:512
    ds_read_b128 v[108:111], v60 offset:768
    v_lshlrev_b32 v13, 12, v3
    v_lshl_add_u32 v13, v2, 3, v13
    s_add_u32 s61, s59, 458752
    s_waitcnt lgkmcnt(0)
    v_pk_add_f32 v[96:97], v[96:97], v[100:101]
    v_pk_add_f32 v[104:105], v[104:105], v[108:109]
    v_pk_add_f32 v[98:99], v[98:99], v[102:103]
    v_pk_add_f32 v[106:107], v[106:107], v[110:111]
    v_pk_add_f32 v[96:97], v[96:97], v[104:105]
    v_pk_add_f32 v[98:99], v[98:99], v[106:107]
    v_cvt_pk_bf16_f32 v64, v96, v97
    v_cvt_pk_bf16_f32 v65, v98, v99
    s_and_b32 exec_lo, s16, 0xf000f
    s_and_b32 exec_hi, s16, 0xf000f
    buffer_store_dwordx2 v[64:65], v13, s[32:35], s61 offen sc1
    s_mov_b64 exec, s[16:17]
Llm_6:
    s_add_u32 s63, s57, 3
    s_and_b32 s63, s63, 3
    s_lshl_b32 s63, s63, 5
    s_add_u32 s63, s63, s52
    s_lshl_b32 s63, s63, 15
    s_add_u32 s63, s63, s67
    s_lshl_b32 s62, s52, 13
    s_add_u32 s62, s62, 98304
    s_mov_b32 s61, s63
    s_mov_b32 m0, s62
    s_add_u32 s62, s62, 1024
    buffer_load_dwordx4 v8, s[36:39], s61 offen  lds
    s_add_u32 s61, s61, 8192
    s_mov_b32 m0, s62
    s_add_u32 s62, s62, 1024
    buffer_load_dwordx4 v8, s[36:39], s61 offen  lds
    s_add_u32 s61, s61, 8192
    s_mov_b32 m0, s62
    s_add_u32 s62, s62, 1024
    buffer_load_dwordx4 v8, s[36:39], s61 offen  lds
    s_add_u32 s61, s61, 8192
    s_mov_b32 m0, s62
    s_add_u32 s62, s62, 1024
    buffer_load_dwordx4 v8, s[36:39], s61 offen  lds
    s_add_u32 s61, s61, 8192
    s_mov_b32 s61, s63
    s_mov_b32 m0, s62
    s_add_u32 s62, s62, 1024
    buffer_load_dwordx4 v9, s[36:39], s61 offen  lds
    s_add_u32 s61, s61, 8192
    s_mov_b32 m0, s62
    s_add_u32 s62, s62, 1024
    buffer_load_dwordx4 v9, s[36:39], s61 offen  lds
    s_add_u32 s61, s61, 8192
    s_mov_b32 m0, s62
    s_add_u32 s62, s62, 1024
    buffer_load_dwordx4 v9, s[36:39], s61 offen  lds
    s_add_u32 s61, s61, 8192
    s_mov_b32 m0, s62
    s_add_u32 s62, s62, 1024
    buffer_load_dwordx4 v9, s[36:39], s61 offen  lds
    s_add_u32 s61, s61, 8192
    ds_read_b64_tr_b16 a[0:1], v10 offset:0
    ds_read_b64_tr_b16 a[2:3], v10 offset:2048
    ds_read_b64_tr_b16 a[4:5], v10 offset:8
    ds_read_b64_tr_b16 a[6:7], v10 offset:2056
    ds_read_b64_tr_b16 a[8:9], v10 offset:8192
    ds_read_b64_tr_b16 a[10:11], v10 offset:10240
    ds_read_b64_tr_b16 a[12:13], v10 offset:8200
    ds_read_b64_tr_b16 a[14:15], v10 offset:10248
    ds_read_b64_tr_b16 a[16:17], v10 offset:16384
    ds_read_b64_tr_b16 a[18:19], v10 offset:18432
    ds_read_b64_tr_b16 a[20:21], v10 offset:16392
    ds_read_b64_tr_b16 a[22:23], v10 offset:18440
    ds_read_b64_tr_b16 a[24:25], v10 offset:24576
    ds_read_b64_tr_b16 a[26:27], v10 offset:26624
    ds_read_b64_tr_b16 a[28:29], v10 offset:24584
    ds_read_b64_tr_b16 a[30:31], v10 offset:26632
    s_waitcnt vmcnt(16)
    s_barrier
    ds_read_b64_tr_b16 a[32:33], v10 offset:32768
    ds_read_b64_tr_b16 a[34:35], v10 offset:34816
    ds_read_b64_tr_b16 a[36:37], v10 offset:32776
    ds_read_b64_tr_b16 a[38:39], v10 offset:34824
    ds_read_b64_tr_b16 a[40:41], v10 offset:40960
    ds_read_b64_tr_b16 a[42:43], v10 offset:43008
    ds_read_b64_tr_b16 a[44:45], v10 offset:40968
    ds_read_b64_tr_b16 a[46:47], v10 offset:43016
    ds_read_b64_tr_b16 a[48:49], v10 offset:49152
    ds_read_b64_tr_b16 a[50:51], v10 offset:51200
    ds_read_b64_tr_b16 a[52:53], v10 offset:49160
    ds_read_b64_tr_b16 a[54:55], v10 offset:51208
    ds_read_b64_tr_b16 a[56:57], v10 offset:57344
    ds_read_b64_tr_b16 a[58:59], v10 offset:59392
    ds_read_b64_tr_b16 a[60:61], v10 offset:57352
    ds_read_b64_tr_b16 a[62:63], v10 offset:59400
    s_waitcnt vmcnt(8)
    s_barrier
    ds_read_b64_tr_b16 a[64:65], v11 offset:0
    ds_read_b64_tr_b16 a[66:67], v11 offset:2048
    ds_read_b64_tr_b16 a[68:69], v11 offset:8
    ds_read_b64_tr_b16 a[70:71], v11 offset:2056
    ds_read_b64_tr_b16 a[72:73], v11 offset:8192
    ds_read_b64_tr_b16 a[74:75], v11 offset:10240
    ds_read_b64_tr_b16 a[76:77], v11 offset:8200
    ds_read_b64_tr_b16 a[78:79], v11 offset:10248
    ds_read_b64_tr_b16 a[80:81], v11 offset:16384
    ds_read_b64_tr_b16 a[82:83], v11 offset:18432
    ds_read_b64_tr_b16 a[84:85], v11 offset:16392
    ds_read_b64_tr_b16 a[86:87], v11 offset:18440
    ds_read_b64_tr_b16 a[88:89], v11 offset:24576
    ds_read_b64_tr_b16 a[90:91], v11 offset:26624
    ds_read_b64_tr_b16 a[92:93], v11 offset:24584
    ds_read_b64_tr_b16 a[94:95], v11 offset:26632
    s_waitcnt vmcnt(0)
    s_barrier
    ds_read_b64_tr_b16 a[96:97], v11 offset:32768
    ds_read_b64_tr_b16 a[98:99], v11 offset:34816
    ds_read_b64_tr_b16 a[100:101], v11 offset:32776
    ds_read_b64_tr_b16 a[102:103], v11 offset:34824
    ds_read_b64_tr_b16 a[104:105], v11 offset:40960
    ds_read_b64_tr_b16 a[106:107], v11 offset:43008
    ds_read_b64_tr_b16 a[108:109], v11 offset:40968
    ds_read_b64_tr_b16 a[110:111], v11 offset:43016
    ds_read_b64_tr_b16 a[112:113], v11 offset:49152
    ds_read_b64_tr_b16 a[114:115], v11 offset:51200
    ds_read_b64_tr_b16 a[116:117], v11 offset:49160
    ds_read_b64_tr_b16 a[118:119], v11 offset:51208
    ds_read_b64_tr_b16 a[120:121], v11 offset:57344
    ds_read_b64_tr_b16 a[122:123], v11 offset:59392
    ds_read_b64_tr_b16 a[124:125], v11 offset:57352
    ds_read_b64_tr_b16 a[126:127], v11 offset:59400
    s_lshr_b32 s60, s55, 0
    s_and_b32 s61, s60, 1
    s_and_b32 s60, s60, 2
    s_lshl_b32 s60, s60, 15
    s_or_b32 s44, s60, s61
    s_lshr_b32 s60, s55, 2
    s_and_b32 s61, s60, 1
    s_and_b32 s60, s60, 2
    s_lshl_b32 s60, s60, 15
    s_or_b32 s45, s60, s61
    s_lshr_b32 s60, s55, 4
    s_and_b32 s61, s60, 1
    s_and_b32 s60, s60, 2
    s_lshl_b32 s60, s60, 15
    s_or_b32 s46, s60, s61
    s_lshr_b32 s60, s55, 6
    s_and_b32 s61, s60, 1
    s_and_b32 s60, s60, 2
    s_lshl_b32 s60, s60, 15
    s_or_b32 s47, s60, s61
    v_mov_b32 v58, 0x00010001
    s_lshr_b32 s71, s54, 2
    s_or_b32 s71, s71, s52
    s_lshl_b32 s70, s53, 2
    s_add_u32 s70, s70, s57
    s_lshl_b32 s70, s70, 7
    s_add_u32 s70, s70, 172032
    v_mov_b32 v60, s55
    s_lshl_b32 s61, s52, 6
    s_add_u32 s61, s61, 161792
    v_add_u32 v62, s61, v56
    v_lshlrev_b32 v63, 4, v1
    v_add_u32 v63, 161792, v63
    s_cmp_lg_u32 s52, 0
    s_cbranch_scc1 Lhs_7
    s_mov_b32 exec_lo, s16
    s_mov_b32 exec_hi, 0
    s_mov_b32 s63, 0
Lp_8:
    buffer_load_dword v15, v22, s[32:35], s66 offen sc1
Lpc_10:
    s_waitcnt vmcnt(0)
    v_cmp_ne_u32 vcc, s55, v15
    s_cbranch_vccz Lpd_9
    s_add_u32 s63, s63, 1
    s_cmp_lt_u32 s63, 30000
    s_cbranch_scc1 Lp_8
Lpd_9:
    s_mov_b64 exec, s[16:17]
Lhs_7:
    s_barrier
    s_mov_b32 s63, 0
L_p4:
    buffer_load_dwordx4 v[28:31], v22, s[32:35], s64 offen sc1
    s_mov_b32 s61, s65
    buffer_load_dwordx4 v[64:67], v23, s[32:35], s61 offen sc1
    s_add_u32 s61, s61, 4096
    buffer_load_dwordx4 v[68:71], v23, s[32:35], s61 offen sc1
    s_add_u32 s61, s61, 4096
    buffer_load_dwordx4 v[72:75], v23, s[32:35], s61 offen sc1
    s_add_u32 s61, s61, 4096
    buffer_load_dwordx4 v[76:79], v23, s[32:35], s61 offen sc1
    s_add_u32 s61, s61, 4096
    buffer_load_dwordx4 v[80:83], v23, s[32:35], s61 offen sc1
    s_add_u32 s61, s61, 4096
    buffer_load_dwordx4 v[84:87], v23, s[32:35], s61 offen sc1
    s_add_u32 s61, s61, 4096
    buffer_load_dwordx4 v[88:91], v23, s[32:35], s61 offen sc1
    s_add_u32 s61, s61, 4096
    buffer_load_dwordx4 v[92:95], v23, s[32:35], s61 offen sc1
    s_waitcnt vmcnt(8)
    v_xor_b32 v61, s55, v30
    v_mov_b32 v32, v28
    s_nop 1
    v_max_f32_dpp v32, v32, v32 row_ror:8 row_mask:0xf bank_mask:0xf
    s_nop 1
    v_max_f32_dpp v32, v32, v32 row_ror:4 row_mask:0xf bank_mask:0xf
    s_nop 1
    v_max_f32_dpp v32, v32, v32 row_ror:2 row_mask:0xf bank_mask:0xf
    s_nop 1
    v_max_f32_dpp v32, v32, v32 row_ror:1 row_mask:0xf bank_mask:0xf
    v_mov_b32 v33, v32
    s_nop 1
    v_permlane16_swap_b32 v32, v33
    v_max_f32 v32, v32, v33
    v_sub_f32 v32, v28, v32
    v_exp_f32 v32, v32
    s_nop 0
    v_mul_f32 v34, v32, v29
    s_nop 1
    v_add_f32_dpp v34, v34, v34 row_ror:8 row_mask:0xf bank_mask:0xf
    s_nop 1
    v_add_f32_dpp v34, v34, v34 row_ror:4 row_mask:0xf bank_mask:0xf
    s_nop 1
    v_add_f32_dpp v34, v34, v34 row_ror:2 row_mask:0xf bank_mask:0xf
    s_nop 1
    v_add_f32_dpp v34, v34, v34 row_ror:1 row_mask:0xf bank_mask:0xf
    v_mov_b32 v33, v34
    s_nop 1
    v_permlane16_swap_b32 v34, v33
    v_add_f32 v34, v34, v33
    v_rcp_f32 v34, v34
    v_mul_f32 v32, 0x3f805879, v32
    v_mul_f32 v32, v32, v34
    v_cvt_pk_bf16_f32 v33, v32, v32
    v_lshlrev_b32 v33, 16, v33
    v_sub_f32 v34, v32, v33
    v_cvt_pk_bf16_f32 v33, v33, v34
    ds_write_b32 v24, v33
    s_waitcnt lgkmcnt(0)
    ds_read_b128 v[36:39], v25
    ds_read_b128 v[40:43], v25 offset:16
    s_waitcnt lgkmcnt(0)
    v_perm_b32 v33, v36, v36, v20
    v_and_b32 v128, v33, v16
    v_and_b32 v129, v33, v17
    v_and_b32 v130, v33, v18
    v_and_b32 v131, v33, v19
    v_perm_b32 v33, v37, v37, v20
    v_and_b32 v132, v33, v16
    v_and_b32 v133, v33, v17
    v_and_b32 v134, v33, v18
    v_and_b32 v135, v33, v19
    v_perm_b32 v33, v38, v38, v20
    v_and_b32 v136, v33, v16
    v_and_b32 v137, v33, v17
    v_and_b32 v138, v33, v18
    v_and_b32 v139, v33, v19
    v_perm_b32 v33, v39, v39, v20
    v_and_b32 v140, v33, v16
    v_and_b32 v141, v33, v17
    v_and_b32 v142, v33, v18
    v_and_b32 v143, v33, v19
    v_perm_b32 v33, v40, v40, v20
    v_and_b32 v144, v33, v16
    v_and_b32 v145, v33, v17
    v_and_b32 v146, v33, v18
    v_and_b32 v147, v33, v19
    v_perm_b32 v33, v41, v41, v20
    v_and_b32 v148, v33, v16
    v_and_b32 v149, v33, v17
    v_and_b32 v150, v33, v18
    v_and_b32 v151, v33, v19
    v_perm_b32 v33, v42, v42, v20
    v_and_b32 v152, v33, v16
    v_and_b32 v153, v33, v17
    v_and_b32 v154, v33, v18
    v_and_b32 v155, v33, v19
    v_perm_b32 v33, v43, v43, v20
    v_and_b32 v156, v33, v16
    v_and_b32 v157, v33, v17
    v_and_b32 v158, v33, v18
    v_and_b32 v159, v33, v19
    s_waitcnt vmcnt(0)
L_p4w:
    v_xor_b32 v64, s44, v64
    v_xor_b32 v65, s45, v65
    v_xor_b32 v66, s46, v66
    v_xor_b32 v67, s47, v67
    v_mov_b32 v13, 0
    v_mov_b32 v14, 0
    v_mfma_f32_16x16x32_bf16 v[44:47], v[128:131], v[64:67], 0
    v_xor_b32 v68, s44, v68
    v_xor_b32 v69, s45, v69
    v_xor_b32 v70, s46, v70
    v_xor_b32 v71, s47, v71
    v_or3_b32 v13, v13, v64, v65
    v_or3_b32 v14, v14, v66, v67
    v_mfma_f32_16x16x32_bf16 v[44:47], v[132:135], v[68:71], v[44:47]
    v_xor_b32 v72, s44, v72
    v_xor_b32 v73, s45, v73
    v_xor_b32 v74, s46, v74
    v_xor_b32 v75, s47, v75
    v_or3_b32 v13, v13, v68, v69
    v_or3_b32 v14, v14, v70, v71
    v_mfma_f32_16x16x32_bf16 v[44:47], v[136:139], v[72:75], v[44:47]
    v_xor_b32 v76, s44, v76
    v_xor_b32 v77, s45, v77
    v_xor_b32 v78, s46, v78
    v_xor_b32 v79, s47, v79
    v_or3_b32 v13, v13, v72, v73
    v_or3_b32 v14, v14, v74, v75
    v_mfma_f32_16x16x32_bf16 v[44:47], v[140:143], v[76:79], v[44:47]
    v_xor_b32 v80, s44, v80
    v_xor_b32 v81, s45, v81
    v_xor_b32 v82, s46, v82
    v_xor_b32 v83, s47, v83
    v_or3_b32 v13, v13, v76, v77
    v_or3_b32 v14, v14, v78, v79
    v_mfma_f32_16x16x32_bf16 v[44:47], v[144:147], v[80:83], v[44:47]
    v_xor_b32 v84, s44, v84
    v_xor_b32 v85, s45, v85
    v_xor_b32 v86, s46, v86
    v_xor_b32 v87, s47, v87
    v_or3_b32 v13, v13, v80, v81
    v_or3_b32 v14, v14, v82, v83
    v_mfma_f32_16x16x32_bf16 v[44:47], v[148:151], v[84:87], v[44:47]
    v_xor_b32 v88, s44, v88
    v_xor_b32 v89, s45, v89
    v_xor_b32 v90, s46, v90
    v_xor_b32 v91, s47, v91
    v_or3_b32 v13, v13, v84, v85
    v_or3_b32 v14, v14, v86, v87
    v_mfma_f32_16x16x32_bf16 v[44:47], v[152:155], v[88:91], v[44:47]
    v_xor_b32 v92, s44, v92
    v_xor_b32 v93, s45, v93
    v_xor_b32 v94, s46, v94
    v_xor_b32 v95, s47, v95
    v_or3_b32 v13, v13, v88, v89
    v_or3_b32 v14, v14, v90, v91
    v_mfma_f32_16x16x32_bf16 v[44:47], v[156:159], v[92:95], v[44:47]
    v_or3_b32 v13, v13, v92, v93
    v_or3_b32 v14, v14, v94, v95
    v_or_b32 v13, v13, v14
    v_and_or_b32 v13, v13, v58, v61
    v_cmp_ne_u32 vcc, 0, v13
    s_cbranch_vccz L_p4d
    s_add_u32 s63, s63, 1
    s_cmp_lt_u32 s63, 7500
    s_cbranch_scc1 L_p4
L_p4d:
    s_nop 1
    v_mov_b32 v48, v44
    v_mov_b32 v49, v45
    v_mov_b32 v50, v46
    v_mov_b32 v51, v47
    v_permlane32_swap_b32 v44, v48
    v_permlane32_swap_b32 v45, v49
    v_permlane32_swap_b32 v46, v50
    v_permlane32_swap_b32 v47, v51
    v_pk_add_f32 v[44:45], v[44:45], v[48:49]
    v_pk_add_f32 v[46:47], v[46:47], v[50:51]
    v_cvt_pk_bf16_f32 v44, v44, v45
    v_cvt_pk_bf16_f32 v45, v46, v47
    ds_write_b64 v26, v[44:45]
    s_waitcnt lgkmcnt(0)
    s_barrier
    ds_read_b128 v[64:67], v27 offset:0
    ds_read_b128 v[68:71], v27 offset:64
    ds_read_b128 v[72:75], v27 offset:128
    ds_read_b128 v[76:79], v27 offset:192
    ds_read_b128 v[80:83], v27 offset:256
    ds_read_b128 v[84:87], v27 offset:320
    ds_read_b128 v[88:91], v27 offset:384
    ds_read_b128 v[92:95], v27 offset:448
    ds_read_b128 v[96:99], v27 offset:512
    ds_read_b128 v[100:103], v27 offset:576
    ds_read_b128 v[104:107], v27 offset:640
    ds_read_b128 v[108:111], v27 offset:704
    ds_read_b128 v[112:115], v27 offset:768
    ds_read_b128 v[116:119], v27 offset:832
    ds_read_b128 v[120:123], v27 offset:896
    ds_read_b128 v[124:127], v27 offset:960
    v_lshlrev_b32 v61, 4, v1
    s_waitcnt lgkmcnt(15)
    v_mfma_f32_16x16x32_bf16 v[44:47], a[0:3], v[64:67], 0
    v_mfma_f32_16x16x32_bf16 v[48:51], a[4:7], v[64:67], 0
    s_waitcnt lgkmcnt(14)
    v_mfma_f32_16x16x32_bf16 v[44:47], a[8:11], v[68:71], v[44:47]
    v_mfma_f32_16x16x32_bf16 v[48:51], a[12:15], v[68:71], v[48:51]
    s_waitcnt lgkmcnt(13)
    v_mfma_f32_16x16x32_bf16 v[44:47], a[16:19], v[72:75], v[44:47]
    v_mfma_f32_16x16x32_bf16 v[48:51], a[20:23], v[72:75], v[48:51]
    s_waitcnt lgkmcnt(12)
    v_mfma_f32_16x16x32_bf16 v[44:47], a[24:27], v[76:79], v[44:47]
    v_mfma_f32_16x16x32_bf16 v[48:51], a[28:31], v[76:79], v[48:51]
    s_waitcnt lgkmcnt(11)
    v_mfma_f32_16x16x32_bf16 v[44:47], a[32:35], v[80:83], v[44:47]
    v_mfma_f32_16x16x32_bf16 v[48:51], a[36:39], v[80:83], v[48:51]
    s_waitcnt lgkmcnt(10)
    v_mfma_f32_16x16x32_bf16 v[44:47], a[40:43], v[84:87], v[44:47]
    v_mfma_f32_16x16x32_bf16 v[48:51], a[44:47], v[84:87], v[48:51]
    s_waitcnt lgkmcnt(9)
    v_mfma_f32_16x16x32_bf16 v[44:47], a[48:51], v[88:91], v[44:47]
    v_mfma_f32_16x16x32_bf16 v[48:51], a[52:55], v[88:91], v[48:51]
    s_waitcnt lgkmcnt(8)
    v_mfma_f32_16x16x32_bf16 v[44:47], a[56:59], v[92:95], v[44:47]
    v_mfma_f32_16x16x32_bf16 v[48:51], a[60:63], v[92:95], v[48:51]
    s_waitcnt lgkmcnt(7)
    v_mfma_f32_16x16x32_bf16 v[44:47], a[64:67], v[96:99], v[44:47]
    v_mfma_f32_16x16x32_bf16 v[48:51], a[68:71], v[96:99], v[48:51]
    s_waitcnt lgkmcnt(6)
    v_mfma_f32_16x16x32_bf16 v[44:47], a[72:75], v[100:103], v[44:47]
    v_mfma_f32_16x16x32_bf16 v[48:51], a[76:79], v[100:103], v[48:51]
    s_waitcnt lgkmcnt(5)
    v_mfma_f32_16x16x32_bf16 v[44:47], a[80:83], v[104:107], v[44:47]
    v_mfma_f32_16x16x32_bf16 v[48:51], a[84:87], v[104:107], v[48:51]
    s_waitcnt lgkmcnt(4)
    v_mfma_f32_16x16x32_bf16 v[44:47], a[88:91], v[108:111], v[44:47]
    v_mfma_f32_16x16x32_bf16 v[48:51], a[92:95], v[108:111], v[48:51]
    s_waitcnt lgkmcnt(3)
    v_mfma_f32_16x16x32_bf16 v[44:47], a[96:99], v[112:115], v[44:47]
    v_mfma_f32_16x16x32_bf16 v[48:51], a[100:103], v[112:115], v[48:51]
    s_waitcnt lgkmcnt(2)
    v_mfma_f32_16x16x32_bf16 v[44:47], a[104:107], v[116:119], v[44:47]
    v_mfma_f32_16x16x32_bf16 v[48:51], a[108:111], v[116:119], v[48:51]
    s_waitcnt lgkmcnt(1)
    v_mfma_f32_16x16x32_bf16 v[44:47], a[112:115], v[120:123], v[44:47]
    v_mfma_f32_16x16x32_bf16 v[48:51], a[116:119], v[120:123], v[48:51]
    s_waitcnt lgkmcnt(0)
    v_mfma_f32_16x16x32_bf16 v[44:47], a[120:123], v[124:127], v[44:47]
    v_mfma_f32_16x16x32_bf16 v[48:51], a[124:127], v[124:127], v[48:51]
    s_nop 6
    v_cvt_pk_bf16_f32 v52, v44, v45
    v_cvt_pk_bf16_f32 v53, v46, v47
    v_cvt_pk_bf16_f32 v54, v48, v49
    v_cvt_pk_bf16_f32 v55, v50, v51
    s_and_b32 exec_lo, s16, 0x10001
    s_and_b32 exec_hi, s16, 0x10001
    ds_write_b128 v62, v[52:55]
    s_waitcnt lgkmcnt(0)
    s_barrier
    s_cmp_lg_u32 s52, 0
    s_cbranch_scc1 Lnc_11
    s_and_b32 exec_lo, s16, 0xffff
    s_mov_b32 exec_hi, 0
    ds_read_b128 v[52:55], v63
    s_waitcnt lgkmcnt(0)
    buffer_store_dwordx4 v[52:55], v61, s[32:35], s58 offen sc1
Lnc_11:
    s_mov_b64 exec, s[16:17]
    s_lshr_b32 s61, s57, 1
    s_or_b32 s61, s61, s52
    s_cmp_lg_u32 s61, 0
    s_cbranch_scc1 L_fin
    s_mov_b32 s36, s4
    s_mov_b32 s37, s5
    s_mov_b32 s38, 4096
    s_mov_b32 s39, 0x00020000
    s_mov_b32 s40, s28
    s_mov_b32 s41, s29
    s_mov_b32 s42, 4096
    s_mov_b32 s43, 0x00020000
    v_bfe_u32 v10, v1, 2, 1
    s_lshl_b32 s61, s57, 1
    v_add_u32 v10, s61, v10
    v_and_b32 v11, 3, v1
    v_lshrrev_b32 v9, 3, v1
    v_lshlrev_b32 v12, 10, v10
    v_lshl_add_u32 v12, v11, 3, v12
    s_lshl_b32 s58, s56, 5
    buffer_load_dwordx2 v[16:17], v12, s[36:39], s58 offen
    v_lshlrev_b32 v13, 12, v10
    v_lshl_add_u32 v13, v11, 3, v13
    s_lshl_b32 s64, s56, 5
    s_add_u32 s64, s64, 458752
    s_add_u32 s65, s64, 3072
    v_lshlrev_b32 v14, 6, v10
    v_lshl_add_u32 v14, v11, 3, v14
    v_and_b32 v15, 3, v9
    v_lshl_add_u32 v14, v15, 12, v14
    s_lshr_b32 s66, s56, 1
    s_lshl_b32 s66, s66, 8
    s_and_b32 s61, s56, 1
    s_lshl_b32 s61, s61, 5
    s_add_u32 s66, s66, s61
    s_add_u32 s66, s66, 425984
    v_lshlrev_b32 v8, 7, v1
    s_mov_b32 s62, 180224
    s_and_b32 exec_lo, s16, 0xff
    s_mov_b32 exec_hi, 0
    s_mov_b32 s63, 0
Lp_14:
    buffer_load_dword v15, v8, s[32:35], s62 offen sc1
Lpc_16:
    s_waitcnt vmcnt(0)
    v_cmp_ne_u32 vcc, s55, v15
    s_cbranch_vccz Lpd_15
    s_add_u32 s63, s63, 1
    s_sleep 8
    s_cmp_lt_u32 s63, 30000
    s_cbranch_scc1 Lp_14
Lpd_15:
    s_mov_b64 exec, s[16:17]
    s_mov_b32 s63, 0
Lp_17:
    buffer_load_dwordx2 v[18:19], v13, s[32:35], s64 offen sc1
    buffer_load_dwordx2 v[20:21], v13, s[32:35], s65 offen sc1
    buffer_load_dwordx2 v[22:23], v14, s[32:35], s66 offen sc1
Lpc_19:
    s_waitcnt vmcnt(0)
    v_max3_u32 v15, v18, v19, v20
    v_max3_u32 v15, v15, v21, v22
    v_max_u32 v15, v15, v23
    v_cmp_eq_u32 vcc, -1, v15
    s_cbranch_vccz Lpd_18
    s_add_u32 s63, s63, 1
    s_sleep 3
    s_cmp_lt_u32 s63, 30000
    s_cbranch_scc1 Lp_17
Lpd_18:
    v_lshlrev_b32 v24, 16, v22
    v_and_b32 v25, 0xffff0000, v22
    v_lshlrev_b32 v26, 16, v23
    v_and_b32 v27, 0xffff0000, v23
    v_lshlrev_b32 v14, 13, v9
    v_and_b32 v15, 7, v1
    v_lshl_add_u32 v14, v15, 4, v14
    s_lshl_b32 s66, s56, 8
    s_lshl_b32 s61, s57, 7
    s_add_u32 s66, s66, s61
    s_add_u32 s66, s66, 524288
    v_add_f32_dpp v24, v24, v24 row_ror:8 row_mask:0xf bank_mask:0xf
    v_add_f32_dpp v25, v25, v25 row_ror:8 row_mask:0xf bank_mask:0xf
    v_add_f32_dpp v26, v26, v26 row_ror:8 row_mask:0xf bank_mask:0xf
    v_add_f32_dpp v27, v27, v27 row_ror:8 row_mask:0xf bank_mask:0xf
    v_mov_b32 v28, v24
    v_mov_b32 v29, v25
    s_nop 0
    v_permlane16_swap_b32 v24, v28
    v_permlane16_swap_b32 v25, v29
    v_pk_add_f32 v[24:25], v[24:25], v[28:29]
    v_mov_b32 v28, v26
    v_mov_b32 v29, v27
    s_nop 0
    v_permlane16_swap_b32 v26, v28
    v_permlane16_swap_b32 v27, v29
    v_pk_add_f32 v[26:27], v[26:27], v[28:29]
    v_lshlrev_b32 v28, 16, v18
    v_and_b32 v29, 0xffff0000, v18
    v_lshlrev_b32 v30, 16, v19
    v_and_b32 v31, 0xffff0000, v19
    v_lshlrev_b32 v32, 16, v16
    v_and_b32 v33, 0xffff0000, v16
    v_lshlrev_b32 v34, 16, v17
    v_and_b32 v35, 0xffff0000, v17
    v_lshlrev_b32 v36, 16, v20
    v_and_b32 v37, 0xffff0000, v20
    v_lshlrev_b32 v38, 16, v21
    v_and_b32 v39, 0xffff0000, v21
    v_pk_fma_f32 v[24:25], v[24:25], v[28:29], v[32:33]
    v_pk_fma_f32 v[26:27], v[26:27], v[30:31], v[34:35]
    s_add_u32 s44, s66, 65536
    s_add_u32 s45, s66, 131072
    s_add_u32 s46, s66, 196608
    s_add_u32 s47, s66, 262144
    s_add_u32 s48, s66, 327680
    s_add_u32 s49, s66, 393216
    v_lshlrev_b32 v10, 7, v1
    s_mov_b32 s62, 188416
    s_and_b32 exec_lo, s16, 0x7f
    s_mov_b32 exec_hi, 0
    s_mov_b32 s63, 0
Lp_21:
    buffer_load_dword v15, v10, s[32:35], s62 offen sc1
Lpc_23:
    s_waitcnt vmcnt(0)
    v_cmp_ne_u32 vcc, s55, v15
    s_cbranch_vccz Lpd_22
    s_add_u32 s63, s63, 1
    s_cmp_lt_u32 s63, 30000
    s_cbranch_scc1 Lp_21
Lpd_22:
    s_mov_b64 exec, s[16:17]
    s_mov_b32 s63, 0
Lp_24:
    buffer_load_dwordx4 v[64:67], v14, s[32:35], s66 offen sc1
    buffer_load_dwordx4 v[68:71], v14, s[32:35], s44 offen sc1
    buffer_load_dwordx4 v[72:75], v14, s[32:35], s45 offen sc1
    buffer_load_dwordx4 v[76:79], v14, s[32:35], s46 offen sc1
    buffer_load_dwordx4 v[80:83], v14, s[32:35], s47 offen sc1
    buffer_load_dwordx4 v[84:87], v14, s[32:35], s48 offen sc1
    buffer_load_dwordx4 v[88:91], v14, s[32:35], s49 offen sc1
Lpc_26:
    s_waitcnt vmcnt(0)
    v_pk_add_f32 v[64:65], v[64:65], v[88:89]
    v_pk_add_f32 v[66:67], v[66:67], v[90:91]
    v_pk_add_f32 v[68:69], v[68:69], v[84:85]
    v_pk_add_f32 v[70:71], v[70:71], v[86:87]
    v_pk_add_f32 v[72:73], v[72:73], v[80:81]
    v_pk_add_f32 v[74:75], v[74:75], v[82:83]
    v_pk_add_f32 v[64:65], v[64:65], v[76:77]
    v_pk_add_f32 v[66:67], v[66:67], v[78:79]
    v_pk_add_f32 v[68:69], v[68:69], v[72:73]
    v_pk_add_f32 v[70:71], v[70:71], v[74:75]
    v_pk_add_f32 v[64:65], v[64:65], v[68:69]
    v_pk_add_f32 v[66:67], v[66:67], v[70:71]
    v_add_f32 v13, v64, v65
    v_add_f32 v15, v66, v67
    v_cmp_u_f32 vcc, v13, v15
    s_cbranch_vccz Lpd_25
    s_add_u32 s63, s63, 1
    s_cmp_lt_u32 s63, 30000
    s_cbranch_scc1 Lp_24
Lpd_25:
    v_add_f32_dpp v64, v64, v64 row_ror:8 row_mask:0xf bank_mask:0xf
    v_add_f32_dpp v65, v65, v65 row_ror:8 row_mask:0xf bank_mask:0xf
    v_add_f32_dpp v66, v66, v66 row_ror:8 row_mask:0xf bank_mask:0xf
    v_add_f32_dpp v67, v67, v67 row_ror:8 row_mask:0xf bank_mask:0xf
    v_mov_b32 v68, v64
    v_mov_b32 v69, v65
    v_mov_b32 v70, v66
    v_mov_b32 v71, v67
    v_permlane16_swap_b32 v64, v68
    v_permlane16_swap_b32 v65, v69
    v_permlane16_swap_b32 v66, v70
    v_permlane16_swap_b32 v67, v71
    v_pk_add_f32 v[64:65], v[64:65], v[68:69]
    v_pk_add_f32 v[66:67], v[66:67], v[70:71]
    v_mov_b32 v68, v64
    v_mov_b32 v69, v65
    v_mov_b32 v70, v66
    v_mov_b32 v71, v67
    v_permlane32_swap_b32 v64, v68
    v_permlane32_swap_b32 v65, v69
    v_permlane32_swap_b32 v66, v70
    v_permlane32_swap_b32 v67, v71
    v_pk_add_f32 v[64:65], v[64:65], v[68:69]
    v_pk_add_f32 v[66:67], v[66:67], v[70:71]
    v_pk_fma_f32 v[64:65], v[64:65], v[36:37], v[24:25]
    v_pk_fma_f32 v[66:67], v[66:67], v[38:39], v[26:27]
    v_cvt_pk_bf16_f32 v64, v64, v65
    v_cvt_pk_bf16_f32 v65, v66, v67
    s_and_b32 exec_lo, s16, 0xff
    s_mov_b32 exec_hi, 0
    buffer_store_dwordx2 v[64:65], v12, s[40:43], s58 offen
    s_or_b32 s61, s56, s57
    s_cmp_lg_u32 s61, 0
    s_cbranch_scc1 L_fin
    s_mov_b64 exec, 1
    v_mov_b32 v13, s55
    v_mov_b32 v14, 0
    buffer_store_dword v13, v14, s[32:35], 0 offen sc1
    s_branch L_fin
L_A:
    s_sub_u32 s58, s54, 16
    s_lshr_b32 s56, s53, 1
    s_and_b32 s60, s53, 1
    s_lshl_b32 s60, s60, 4
    s_add_u32 s57, s60, s58
    s_lshl_b32 s60, s56, 5
    s_add_u32 s59, s60, s57
    s_lshl_b32 s66, s52, 15
    v_lshlrev_b32 v8, 4, v1
    v_mov_b32 v16, -1
    v_mov_b32 v17, -1
    v_mov_b32 v18, -1
    v_mov_b32 v19, -1
    s_lshr_b32 s60, s58, 3
    s_lshl_b32 s60, s60, 6
    s_lshl_b32 s61, s53, 3
    s_add_u32 s60, s60, s61
    s_and_b32 s61, s58, 7
    s_add_u32 s67, s60, s61
    v_and_b32 v10, 3, v3
    v_lshlrev_b32 v10, 10, v10
    v_lshrrev_b32 v15, 2, v3
    v_lshl_add_u32 v10, v15, 6, v10
    v_lshl_add_u32 v10, v2, 4, v10
    s_lshl_b32 s60, s52, 8
    v_add_u32 v10, s60, v10
    v_lshrrev_b32 v12, 1, v1
    v_and_b32 v13, 1, v1
    v_lshl_add_u32 v12, v13, 5, v12
    v_mul_u32_u24 v12, 6144, v12
    s_lshl_b32 s61, s67, 4
    s_mul_i32 s62, s52, 786432
    s_add_u32 s64, s61, s62
    s_lshl_b32 s62, s52, 11
    s_add_u32 s65, s62, 131072
    s_waitcnt lgkmcnt(0)
    s_mov_b64 s[16:17], -1
    s_and_b32 exec_lo, s16, 0xff
    s_mov_b32 exec_hi, 0
    global_load_dword v5, v7, s[26:27]
    s_mov_b64 exec, s[16:17]
    s_mov_b32 s32, s30
    s_mov_b32 s33, s31
    s_mov_b32 s34, 268435456
    s_mov_b32 s35, 0x00020000
    buffer_load_dword v6, v4, s[32:35], 0 offen sc1
    s_mov_b32 s44, s24
    s_mov_b32 s45, s25
    s_mov_b32 s46, 4096
    s_mov_b32 s47, 0x00020000
    buffer_load_dwordx4 v[48:51], v10, s[44:47], 0 offen
    s_mov_b32 s40, s26
    s_mov_b32 s41, s27
    s_mov_b32 s42, 3145728
    s_mov_b32 s43, 0x00020000
    s_mov_b32 m0, s65
    s_add_u32 s65, s65, 1024
    buffer_load_dwordx4 v12, s[40:43], s64 offen  lds
    s_add_u32 s64, s64, 393216
    s_mov_b32 m0, s65
    s_add_u32 s65, s65, 1024
    buffer_load_dwordx4 v12, s[40:43], s64 offen  lds
    s_add_u32 s64, s64, 393216
    s_lshl_b32 s61, s67, 2
    s_add_u32 s61, s61, s52
    s_lshl_b32 s61, s61, 9
    s_add_u32 s61, s61, 262144
    s_mov_b32 exec_lo, s16
    s_mov_b32 exec_hi, 0
    buffer_store_dwordx4 v[16:19], v8, s[32:35], s61 offen sc1
    s_mov_b64 exec, s[16:17]
L_A2:
    s_lshl_b32 s60, s59, 17
    s_add_u32 s36, s6, s60
    s_addc_u32 s37, s7, 0
    s_mov_b32 s38, 131072
    s_mov_b32 s39, 0x00020000
    v_and_b32 v24, 3, v3
    v_lshlrev_b32 v24, 5, v24
    v_and_b32 v13, 1, v2
    v_lshl_add_u32 v27, v13, 4, v24
    v_add_u32 v25, 147456, v27
    v_lshrrev_b32 v13, 1, v2
    v_lshl_add_u32 v24, v13, 7, v25
    s_lshl_b32 s61, s52, 8
    v_add_u32 v24, s61, v24
    v_bfe_u32 v26, v1, 2, 2
    v_lshlrev_b32 v26, 5, v26
    v_lshl_add_u32 v26, v2, 8, v26
    v_and_b32 v14, 3, v1
    v_lshl_add_u32 v26, v14, 3, v26
    s_lshl_b32 s60, s52, 11
    s_add_u32 s60, s60, 131072
    v_add_u32 v26, s60, v26
    s_lshl_b32 s61, s67, 7
    s_add_u32 s64, s61, 131072
    s_cmp_ge_u32 s58, 8
    s_cselect_b32 s70, 1.0, 0
    s_waitcnt vmcnt(3)
    v_readfirstlane_b32 s55, v6
    s_nop 0
    s_add_u32 s55, s55, 1
    v_lshlrev_b32 v64, 16, v48
    v_and_b32 v65, 0xffff0000, v48
    v_lshlrev_b32 v66, 16, v49
    v_and_b32 v67, 0xffff0000, v49
    v_lshlrev_b32 v68, 16, v50
    v_and_b32 v69, 0xffff0000, v50
    v_lshlrev_b32 v70, 16, v51
    v_and_b32 v71, 0xffff0000, v51
    s_mov_b32 s60, 0xbfb8aa3b
    v_mul_f32 v72, s60, v64
    v_mul_f32 v73, s60, v65
    v_mul_f32 v74, s60, v66
    v_mul_f32 v75, s60, v67
    v_mul_f32 v76, s60, v68
    v_mul_f32 v77, s60, v69
    v_mul_f32 v78, s60, v70
    v_mul_f32 v79, s60, v71
    v_exp_f32 v72, v72
    v_exp_f32 v73, v73
    v_exp_f32 v74, v74
    v_exp_f32 v75, v75
    v_exp_f32 v76, v76
    v_exp_f32 v77, v77
    v_exp_f32 v78, v78
    v_exp_f32 v79, v79
    v_add_f32 v72, 1.0, v72
    v_add_f32 v73, 1.0, v73
    v_add_f32 v74, 1.0, v74
    v_add_f32 v75, 1.0, v75
    v_add_f32 v76, 1.0, v76
    v_add_f32 v77, 1.0, v77
    v_add_f32 v78, 1.0, v78
    v_add_f32 v79, 1.0, v79
    v_rcp_f32 v72, v72
    v_rcp_f32 v73, v73
    v_rcp_f32 v74, v74
    v_rcp_f32 v75, v75
    v_rcp_f32 v76, v76
    v_rcp_f32 v77, v77
    v_rcp_f32 v78, v78
    v_rcp_f32 v79, v79
    v_pk_mul_f32 v[64:65], v[64:65], v[72:73]
    v_pk_mul_f32 v[66:67], v[66:67], v[74:75]
    v_pk_mul_f32 v[68:69], v[68:69], v[76:77]
    v_pk_mul_f32 v[70:71], v[70:71], v[78:79]
    v_cvt_pk_bf16_f32 v48, v64, v65
    v_cvt_pk_bf16_f32 v49, v66, v67
    v_cvt_pk_bf16_f32 v50, v68, v69
    v_cvt_pk_bf16_f32 v51, v70, v71
    v_mov_b32_dpp v52, v48 row_shl:8 row_mask:0xf bank_mask:0xf
    v_mov_b32_dpp v53, v49 row_shl:8 row_mask:0xf bank_mask:0xf
    v_mov_b32_dpp v54, v50 row_shl:8 row_mask:0xf bank_mask:0xf
    v_mov_b32_dpp v55, v51 row_shl:8 row_mask:0xf bank_mask:0xf
    v_mov_b32 v109, s55
    v_mov_b32 v111, s55
    s_waitcnt vmcnt(1)
    ds_read_b64_tr_b16 v[64:65], v26 offset:0
    ds_read_b64_tr_b16 v[66:67], v26 offset:128
    ds_read_b64_tr_b16 v[68:69], v26 offset:1024
    ds_read_b64_tr_b16 v[70:71], v26 offset:1152
    s_waitcnt lgkmcnt(2)
    v_mfma_f32_16x16x32_bf16 v[44:47], v[64:67], v[48:51], 0
    s_waitcnt lgkmcnt(0)
    v_mfma_f32_16x16x32_bf16 v[44:47], v[68:71], v[52:55], v[44:47]
    s_and_b32 exec_lo, s16, 0xf000f
    s_and_b32 exec_hi, s16, 0xf000f0
    s_nop 5
    ds_write_b128 v24, v[44:47]
    s_mov_b64 exec, s[16:17]
    s_waitcnt vmcnt(0) lgkmcnt(0)
    s_barrier
    s_cmp_lg_u32 s52, 0
    s_cbranch_scc1 L_Ap0e
    ds_read_b128 v[128:131], v25 offset:0
    ds_read_b128 v[132:135], v25 offset:128
    ds_read_b128 v[136:139], v25 offset:256
    ds_read_b128 v[140:143], v25 offset:384
    ds_read_b128 v[144:147], v25 offset:512
    ds_read_b128 v[148:151], v25 offset:640
    ds_read_b128 v[152:155], v25 offset:768
    ds_read_b128 v[156:159], v25 offset:896
    s_waitcnt lgkmcnt(4)
    v_pk_add_f32 v[128:129], v[128:129], v[132:133]
    v_pk_add_f32 v[136:137], v[136:137], v[140:141]
    v_pk_add_f32 v[130:131], v[130:131], v[134:135]
    v_pk_add_f32 v[138:139], v[138:139], v[142:143]
    v_pk_add_f32 v[128:129], v[128:129], v[136:137]
    v_pk_add_f32 v[130:131], v[130:131], v[138:139]
    s_waitcnt lgkmcnt(0)
    v_pk_add_f32 v[144:145], v[144:145], v[148:149]
    v_pk_add_f32 v[152:153], v[152:153], v[156:157]
    v_pk_add_f32 v[146:147], v[146:147], v[150:151]
    v_pk_add_f32 v[154:155], v[154:155], v[158:159]
    v_pk_add_f32 v[144:145], v[144:145], v[152:153]
    v_pk_add_f32 v[146:147], v[146:147], v[154:155]
    v_pk_add_f32 v[128:129], v[128:129], v[144:145]
    v_pk_add_f32 v[130:131], v[130:131], v[146:147]
    v_cvt_pk_bf16_f32 v13, v128, v129
    v_lshlrev_b32 v128, 16, v13
    v_and_b32 v129, 0xffff0000, v13
    v_cvt_pk_bf16_f32 v12, v130, v131
    v_lshlrev_b32 v130, 16, v12
    v_and_b32 v131, 0xffff0000, v12
    v_add_f32 v128, s70, v128
    v_add_f32 v129, s70, v129
    v_add_f32 v130, s70, v130
    v_add_f32 v131, s70, v131
    v_cvt_pk_bf16_f32 v108, v128, v129
    v_cvt_pk_bf16_f32 v110, v130, v131
    s_and_b32 exec_lo, s16, 0xf000f
    s_mov_b32 exec_hi, 0
    buffer_store_dwordx4 v[108:111], v27, s[32:35], s64 offen sc1
    s_mov_b64 exec, s[16:17]
L_Ap0e:
    s_barrier
    s_lshl_b32 s61, s56, 20
    s_lshl_b32 s62, s57, 10
    s_add_u32 s65, s61, s62
    s_add_u32 s65, s65, 1048576
    s_lshl_b32 s67, s53, 3
    s_add_u32 s67, s67, s58
    s_cmp_ge_u32 s58, 8
    s_cselect_b32 s67, 64, s67
    s_lshl_b32 s61, s67, 13
    s_lshl_b32 s62, s52, 11
    s_add_u32 s61, s61, s62
    s_add_u32 s61, s61, 524288
    s_cmp_ge_u32 s67, 56
    s_cbranch_scc1 L_nodn
    buffer_store_dwordx4 v[16:19], v8, s[32:35], s61 offen sc1
    buffer_store_dwordx4 v[16:19], v8, s[32:35], s61 offen offset:1024 sc1
L_nodn:
    s_mov_b32 m0, s66
    v_xor_b32 v9, 0, v8
    buffer_load_dwordx4 v9, s[36:39], s66 offen nt lds
    s_add_u32 s66, s66, 1024
    s_mov_b32 m0, s66
    v_xor_b32 v9, 32, v8
    buffer_load_dwordx4 v9, s[36:39], s66 offen nt lds
    s_add_u32 s66, s66, 1024
    s_mov_b32 m0, s66
    v_xor_b32 v9, 64, v8
    buffer_load_dwordx4 v9, s[36:39], s66 offen nt lds
    s_add_u32 s66, s66, 1024
    s_mov_b32 m0, s66
    v_xor_b32 v9, 96, v8
    buffer_load_dwordx4 v9, s[36:39], s66 offen nt lds
    s_add_u32 s66, s66, 1024
    s_mov_b32 m0, s66
    v_xor_b32 v9, 128, v8
    buffer_load_dwordx4 v9, s[36:39], s66 offen nt lds
    s_add_u32 s66, s66, 1024
    s_mov_b32 m0, s66
    v_xor_b32 v9, 160, v8
    buffer_load_dwordx4 v9, s[36:39], s66 offen nt lds
    s_add_u32 s66, s66, 1024
    s_mov_b32 m0, s66
    v_xor_b32 v9, 192, v8
    buffer_load_dwordx4 v9, s[36:39], s66 offen nt lds
    s_add_u32 s66, s66, 1024
    s_mov_b32 m0, s66
    v_xor_b32 v9, 224, v8
    buffer_load_dwordx4 v9, s[36:39], s66 offen nt lds
    s_add_u32 s66, s66, 1024
    s_mov_b32 m0, s66
    v_xor_b32 v9, 0, v8
    buffer_load_dwordx4 v9, s[36:39], s66 offen nt lds
    s_add_u32 s66, s66, 1024
    s_mov_b32 m0, s66
    v_xor_b32 v9, 32, v8
    buffer_load_dwordx4 v9, s[36:39], s66 offen nt lds
    s_add_u32 s66, s66, 1024
    s_mov_b32 m0, s66
    v_xor_b32 v9, 64, v8
    buffer_load_dwordx4 v9, s[36:39], s66 offen nt lds
    s_add_u32 s66, s66, 1024
    s_mov_b32 m0, s66
    v_xor_b32 v9, 96, v8
    buffer_load_dwordx4 v9, s[36:39], s66 offen nt lds
    s_add_u32 s66, s66, 1024
    s_mov_b32 m0, s66
    v_xor_b32 v9, 128, v8
    buffer_load_dwordx4 v9, s[36:39], s66 offen nt lds
    s_add_u32 s66, s66, 1024
    s_mov_b32 m0, s66
    v_xor_b32 v9, 160, v8
    buffer_load_dwordx4 v9, s[36:39], s66 offen nt lds
    s_add_u32 s66, s66, 1024
    s_mov_b32 m0, s66
    v_xor_b32 v9, 192, v8
    buffer_load_dwordx4 v9, s[36:39], s66 offen nt lds
    s_add_u32 s66, s66, 1024
    s_mov_b32 m0, s66
    v_xor_b32 v9, 224, v8
    buffer_load_dwordx4 v9, s[36:39], s66 offen nt lds
    s_add_u32 s66, s66, 1024
    s_mov_b32 m0, s66
    v_xor_b32 v9, 0, v8
    buffer_load_dwordx4 v9, s[36:39], s66 offen nt lds
    s_add_u32 s66, s66, 1024
    s_mov_b32 m0, s66
    v_xor_b32 v9, 32, v8
    buffer_load_dwordx4 v9, s[36:39], s66 offen nt lds
    s_add_u32 s66, s66, 1024
    s_mov_b32 m0, s66
    v_xor_b32 v9, 64, v8
    buffer_load_dwordx4 v9, s[36:39], s66 offen nt lds
    s_add_u32 s66, s66, 1024
    s_mov_b32 m0, s66
    v_xor_b32 v9, 96, v8
    buffer_load_dwordx4 v9, s[36:39], s66 offen nt lds
    s_add_u32 s66, s66, 1024
    s_mov_b32 m0, s66
    v_xor_b32 v9, 128, v8
    buffer_load_dwordx4 v9, s[36:39], s66 offen nt lds
    s_add_u32 s66, s66, 1024
    s_mov_b32 m0, s66
    v_xor_b32 v9, 160, v8
    buffer_load_dwordx4 v9, s[36:39], s66 offen nt lds
    s_add_u32 s66, s66, 1024
    s_mov_b32 m0, s66
    v_xor_b32 v9, 192, v8
    buffer_load_dwordx4 v9, s[36:39], s66 offen nt lds
    s_add_u32 s66, s66, 1024
    s_mov_b32 m0, s66
    v_xor_b32 v9, 224, v8
    buffer_load_dwordx4 v9, s[36:39], s66 offen nt lds
    s_add_u32 s66, s66, 1024
    s_mov_b32 m0, s66
    v_xor_b32 v9, 0, v8
    buffer_load_dwordx4 v9, s[36:39], s66 offen nt lds
    s_add_u32 s66, s66, 1024
    s_mov_b32 m0, s66
    v_xor_b32 v9, 32, v8
    buffer_load_dwordx4 v9, s[36:39], s66 offen nt lds
    s_add_u32 s66, s66, 1024
    s_mov_b32 m0, s66
    v_xor_b32 v9, 64, v8
    buffer_load_dwordx4 v9, s[36:39], s66 offen nt lds
    s_add_u32 s66, s66, 1024
    s_mov_b32 m0, s66
    v_xor_b32 v9, 96, v8
    buffer_load_dwordx4 v9, s[36:39], s66 offen nt lds
    s_add_u32 s66, s66, 1024
    s_mov_b32 m0, s66
    v_xor_b32 v9, 128, v8
    buffer_load_dwordx4 v9, s[36:39], s66 offen nt lds
    s_add_u32 s66, s66, 1024
    s_mov_b32 m0, s66
    v_xor_b32 v9, 160, v8
    buffer_load_dwordx4 v9, s[36:39], s66 offen nt lds
    s_add_u32 s66, s66, 1024
    s_mov_b32 m0, s66
    v_xor_b32 v9, 192, v8
    buffer_load_dwordx4 v9, s[36:39], s66 offen nt lds
    s_add_u32 s66, s66, 1024
    s_mov_b32 m0, s66
    v_xor_b32 v9, 224, v8
    buffer_load_dwordx4 v9, s[36:39], s66 offen nt lds
    s_add_u32 s66, s66, 1024
    v_lshlrev_b32 v206, 7, v1
    s_mov_b32 s64, 131076
    s_mov_b32 s70, 139268
    buffer_load_dword v204, v206, s[32:35], s64 offen sc1
    buffer_load_dword v205, v206, s[32:35], s70 offen sc1
    v_lshrrev_b32 v11, 5, v1
    v_and_b32 v12, 7, v3
    v_lshlrev_b32 v12, 1, v12
    v_xor_b32 v12, v12, v2
    v_lshlrev_b32 v13, 10, v3
    v_lshl_add_u32 v13, v12, 4, v13
    s_lshl_b32 s61, s52, 15
    v_add_u32 v20, s61, v13
    v_add_u32 v24, 131072, v13
    v_xor_b32 v21, 64, v20
    v_xor_b32 v25, 64, v24
    v_xor_b32 v22, 128, v20
    v_xor_b32 v26, 128, v24
    v_xor_b32 v23, 192, v20
    v_xor_b32 v27, 192, v24
    v_lshrrev_b32 v12, 2, v1
    v_and_b32 v13, 7, v12
    v_lshlrev_b32 v12, 10, v12
    v_lshl_add_u32 v12, v13, 5, v12
    v_and_b32 v13, 3, v1
    v_lshl_add_u32 v12, v13, 3, v12
    s_mul_i32 s71, s52, 33024
    v_add_u32 v12, s71, v12
    v_xor_b32 v208, 0, v12
    v_xor_b32 v209, 32, v12
    v_xor_b32 v210, 64, v12
    v_xor_b32 v211, 96, v12
    v_xor_b32 v212, 128, v12
    v_xor_b32 v213, 160, v12
    v_xor_b32 v214, 192, v12
    v_xor_b32 v215, 224, v12
    v_add_u32 v12, 0x8000, v12
    v_and_b32 v12, 0x1ffff, v12
    v_xor_b32 v216, 0, v12
    v_xor_b32 v217, 32, v12
    v_xor_b32 v218, 64, v12
    v_xor_b32 v219, 96, v12
    v_xor_b32 v220, 128, v12
    v_xor_b32 v221, 160, v12
    v_xor_b32 v222, 192, v12
    v_xor_b32 v223, 224, v12
    v_add_u32 v12, 0x8000, v12
    v_and_b32 v12, 0x1ffff, v12
    v_xor_b32 v224, 0, v12
    v_xor_b32 v225, 32, v12
    v_xor_b32 v226, 64, v12
    v_xor_b32 v227, 96, v12
    v_xor_b32 v228, 128, v12
    v_xor_b32 v229, 160, v12
    v_xor_b32 v230, 192, v12
    v_xor_b32 v231, 224, v12
    v_add_u32 v12, 0x8000, v12
    v_and_b32 v12, 0x1ffff, v12
    v_xor_b32 v232, 0, v12
    v_xor_b32 v233, 32, v12
    v_xor_b32 v234, 64, v12
    v_xor_b32 v235, 96, v12
    v_xor_b32 v236, 128, v12
    v_xor_b32 v237, 160, v12
    v_xor_b32 v238, 192, v12
    v_xor_b32 v239, 224, v12
    v_xor_b32 v192, 0, v8
    v_xor_b32 v193, 32, v8
    v_xor_b32 v194, 64, v8
    v_xor_b32 v195, 96, v8
    v_xor_b32 v196, 128, v8
    v_xor_b32 v197, 160, v8
    v_xor_b32 v198, 192, v8
    v_xor_b32 v199, 224, v8
    s_waitcnt vmcnt(0)
    s_mov_b32 s63, 0
    s_branch Lpc_29
Lp_27:
    buffer_load_dword v204, v206, s[32:35], s64 offen sc1
    buffer_load_dword v205, v206, s[32:35], s70 offen sc1
Lpc_29:
    s_waitcnt vmcnt(0)
    v_xor_b32 v204, s55, v204
    v_xor_b32 v205, s55, v205
    v_or_b32 v204, v204, v205
    v_cmp_ne_u32 vcc, 0, v204
    s_cbranch_vccz Lpd_28
    s_add_u32 s63, s63, 1
    s_sleep 4
    s_cmp_lt_u32 s63, 30000
    s_cbranch_scc1 Lp_27
Lpd_28:
    s_lshl_b32 s61, s56, 15
    s_lshl_b32 s62, s52, 13
    s_add_u32 s64, s61, s62
    s_add_u32 s64, s64, 262144
    buffer_load_dword v15, v206, s[32:35], s64 offen sc1
    ds_read_b128 a[0:3], v20 offset:0
    ds_read_b128 a[4:7], v21 offset:0
    ds_read_b128 a[8:11], v22 offset:0
    ds_read_b128 a[12:15], v23 offset:0
    ds_read_b128 a[16:19], v20 offset:256
    ds_read_b128 a[20:23], v21 offset:256
    ds_read_b128 a[24:27], v22 offset:256
    ds_read_b128 a[28:31], v23 offset:256
    ds_read_b128 a[32:35], v20 offset:512
    ds_read_b128 a[36:39], v21 offset:512
    ds_read_b128 a[40:43], v22 offset:512
    ds_read_b128 a[44:47], v23 offset:512
    ds_read_b128 a[48:51], v20 offset:768
    ds_read_b128 a[52:55], v21 offset:768
    ds_read_b128 a[56:59], v22 offset:768
    ds_read_b128 a[60:63], v23 offset:768
    ds_read_b128 a[64:67], v20 offset:16384
    ds_read_b128 a[68:71], v21 offset:16384
    ds_read_b128 a[72:75], v22 offset:16384
    ds_read_b128 a[76:79], v23 offset:16384
    ds_read_b128 a[80:83], v20 offset:16640
    ds_read_b128 a[84:87], v21 offset:16640
    ds_read_b128 a[88:91], v22 offset:16640
    ds_read_b128 a[92:95], v23 offset:16640
    ds_read_b128 a[96:99], v20 offset:16896
    ds_read_b128 a[100:103], v21 offset:16896
    ds_read_b128 a[104:107], v22 offset:16896
    ds_read_b128 a[108:111], v23 offset:16896
    ds_read_b128 a[112:115], v20 offset:17152
    ds_read_b128 a[116:119], v21 offset:17152
    ds_read_b128 a[120:123], v22 offset:17152
    ds_read_b128 a[124:127], v23 offset:17152
    v_bfe_u32 v22, v1, 2, 2
    v_lshlrev_b32 v22, 7, v22
    v_mul_u32_u24 v21, 3584, v2
    v_lshlrev_b32 v23, 10, v2
    s_and_b32 s60, s52, 1
    s_lshl_b32 s61, s58, 1
    s_add_u32 s60, s60, s61
    s_mul_i32 s60, s60, 57344
    s_min_u32 s61, s53, 6
    s_lshl_b32 s61, s61, 9
    s_add_u32 s60, s60, s61
    v_add3_u32 v240, v21, v22, s60
    s_lshr_b32 s60, s53, 1
    s_lshl_b32 s60, s60, 4
    s_add_u32 s60, s60, s58
    s_lshl_b32 s60, s60, 2
    s_add_u32 s60, s60, s52
    s_lshl_b32 s60, s60, 14
    s_and_b32 s61, s53, 1
    s_lshl_b32 s61, s61, 9
    s_add_u32 s60, s60, s61
    v_add3_u32 v244, v23, v22, s60
    v_add_u32 v241, 14336, v240
    v_add_u32 v245, 4096, v244
    v_add_u32 v242, 28672, v240
    v_add_u32 v246, 8192, v244
    v_add_u32 v243, 43008, v240
    v_add_u32 v247, 12288, v244
    s_cmp_ge_u32 s52, 2
    s_cselect_b32 s48, s20, s18
    s_cselect_b32 s49, s21, s19
    s_lshr_b32 s60, s55, 0
    s_and_b32 s61, s60, 1
    s_and_b32 s60, s60, 2
    s_lshl_b32 s60, s60, 15
    s_or_b32 s44, s60, s61
    s_lshr_b32 s60, s55, 2
    s_and_b32 s61, s60, 1
    s_and_b32 s60, s60, 2
    s_lshl_b32 s60, s60, 15
    s_or_b32 s45, s60, s61
    s_lshr_b32 s60, s55, 4
    s_and_b32 s61, s60, 1
    s_and_b32 s60, s60, 2
    s_lshl_b32 s60, s60, 15
    s_or_b32 s46, s60, s61
    s_lshr_b32 s60, s55, 6
    s_and_b32 s61, s60, 1
    s_and_b32 s60, s60, 2
    s_lshl_b32 s60, s60, 15
    s_or_b32 s47, s60, s61
    v_mov_b32 v22, 0x00010001
    v_lshlrev_b32 v28, 2, v3
    v_add_u32 v29, 66048, v28
    v_add_u32 v30, s71, v28
    v_add_u32 v42, 128, v28
    v_add_u32 v43, 128, v29
    s_add_u32 s61, s52, 0
    s_and_b32 s61, s61, 3
    s_lshl_b32 s61, s61, 10
    s_add_u32 s61, s61, 131072
    v_add_u32 v200, s61, v8
    s_add_u32 s61, s52, 1
    s_and_b32 s61, s61, 3
    s_lshl_b32 s61, s61, 10
    s_add_u32 s61, s61, 131072
    v_add_u32 v201, s61, v8
    s_add_u32 s61, s52, 2
    s_and_b32 s61, s61, 3
    s_lshl_b32 s61, s61, 10
    s_add_u32 s61, s61, 131072
    v_add_u32 v202, s61, v8
    s_add_u32 s61, s52, 3
    s_and_b32 s61, s61, 3
    s_lshl_b32 s61, s61, 10
    s_add_u32 s61, s61, 131072
    v_add_u32 v203, s61, v8
    v_lshlrev_b32 v20, 17, v2
    v_lshl_add_u32 v20, v3, 4, v20
    s_lshl_b32 s61, s52, 8
    v_add_u32 v20, s61, v20
    s_lshl_b32 s61, s59, 9
    s_add_u32 s70, s61, 16384
    v_mov_b32 v46, s55
    v_mov_b32 v47, s55
    s_mov_b32 s50, 0x3fb8aa3b
    v_mov_b32 v36, 0x3f803f80
    v_mov_b32 v252, s55
    v_mov_b32 v37, 0x3f803f80
    v_mov_b32 v253, s55
    v_mov_b32 v38, 0x3f803f80
    v_mov_b32 v254, s55
    v_mov_b32 v39, 0x3f803f80
    v_mov_b32 v255, s55
    s_mov_b32 s51, 0x3db504f3
    v_lshlrev_b32 v31, 4, v3
    s_mov_b32 s72, 0xaaaaaaaa
    s_mov_b32 s73, 0xaaaaaaaa
    s_mov_b32 s0, 0xcccccccc
    s_mov_b32 s1, 0xcccccccc
    ds_read_b64_tr_b16 a[128:129], v208 offset:0
    ds_read_b64_tr_b16 a[130:131], v208 offset:16384
    ds_read_b64_tr_b16 a[132:133], v209 offset:0
    ds_read_b64_tr_b16 a[134:135], v209 offset:16384
    ds_read_b64_tr_b16 a[136:137], v210 offset:0
    ds_read_b64_tr_b16 a[138:139], v210 offset:16384
    ds_read_b64_tr_b16 a[140:141], v211 offset:0
    ds_read_b64_tr_b16 a[142:143], v211 offset:16384
    ds_read_b64_tr_b16 a[144:145], v212 offset:0
    ds_read_b64_tr_b16 a[146:147], v212 offset:16384
    ds_read_b64_tr_b16 a[148:149], v213 offset:0
    ds_read_b64_tr_b16 a[150:151], v213 offset:16384
    ds_read_b64_tr_b16 a[152:153], v214 offset:0
    ds_read_b64_tr_b16 a[154:155], v214 offset:16384
    ds_read_b64_tr_b16 a[156:157], v215 offset:0
    ds_read_b64_tr_b16 a[158:159], v215 offset:16384
    s_mov_b32 s63, 0
    s_branch Lpc_32
Lp_30:
    buffer_load_dword v15, v206, s[32:35], s64 offen sc1
Lpc_32:
    s_waitcnt vmcnt(0)
    v_cmp_eq_u32 vcc, -1, v15
    s_cbranch_vccz Lpd_31
    s_add_u32 s63, s63, 1
    s_cmp_lt_u32 s63, 30000
    s_cbranch_scc1 Lp_30
Lpd_31:
    s_mov_b32 s61, s64
    s_lshl_b32 s60, s52, 13
    s_add_u32 s60, s60, 131072
    s_mov_b32 m0, s60
    s_add_u32 s60, s60, 1024
    buffer_load_dwordx4 v192, s[32:35], s61 offen sc1 lds
    s_add_u32 s61, s61, 1024
    s_mov_b32 m0, s60
    s_add_u32 s60, s60, 1024
    buffer_load_dwordx4 v193, s[32:35], s61 offen sc1 lds
    s_add_u32 s61, s61, 1024
    s_mov_b32 m0, s60
    s_add_u32 s60, s60, 1024
    buffer_load_dwordx4 v194, s[32:35], s61 offen sc1 lds
    s_add_u32 s61, s61, 1024
    s_mov_b32 m0, s60
    s_add_u32 s60, s60, 1024
    buffer_load_dwordx4 v195, s[32:35], s61 offen sc1 lds
    s_add_u32 s61, s61, 1024
    s_mov_b32 m0, s60
    s_add_u32 s60, s60, 1024
    buffer_load_dwordx4 v196, s[32:35], s61 offen sc1 lds
    s_add_u32 s61, s61, 1024
    s_mov_b32 m0, s60
    s_add_u32 s60, s60, 1024
    buffer_load_dwordx4 v197, s[32:35], s61 offen sc1 lds
    s_add_u32 s61, s61, 1024
    s_mov_b32 m0, s60
    s_add_u32 s60, s60, 1024
    buffer_load_dwordx4 v198, s[32:35], s61 offen sc1 lds
    s_add_u32 s61, s61, 1024
    s_mov_b32 m0, s60
    s_add_u32 s60, s60, 1024
    buffer_load_dwordx4 v199, s[32:35], s61 offen sc1 lds
    s_add_u32 s61, s61, 1024
    s_barrier
    ds_read_b64_tr_b16 a[160:161], v216 offset:0
    ds_read_b64_tr_b16 a[162:163], v216 offset:16384
    ds_read_b64_tr_b16 a[164:165], v217 offset:0
    ds_read_b64_tr_b16 a[166:167], v217 offset:16384
    ds_read_b64_tr_b16 a[168:169], v218 offset:0
    ds_read_b64_tr_b16 a[170:171], v218 offset:16384
    ds_read_b64_tr_b16 a[172:173], v219 offset:0
    ds_read_b64_tr_b16 a[174:175], v219 offset:16384
    ds_read_b64_tr_b16 a[176:177], v220 offset:0
    ds_read_b64_tr_b16 a[178:179], v220 offset:16384
    ds_read_b64_tr_b16 a[180:181], v221 offset:0
    ds_read_b64_tr_b16 a[182:183], v221 offset:16384
    ds_read_b64_tr_b16 a[184:185], v222 offset:0
    ds_read_b64_tr_b16 a[186:187], v222 offset:16384
    ds_read_b64_tr_b16 a[188:189], v223 offset:0
    ds_read_b64_tr_b16 a[190:191], v223 offset:16384
    ds_read_b64_tr_b16 a[192:193], v224 offset:0
    ds_read_b64_tr_b16 a[194:195], v224 offset:16384
    ds_read_b64_tr_b16 a[196:197], v225 offset:0
    ds_read_b64_tr_b16 a[198:199], v225 offset:16384
    ds_read_b64_tr_b16 a[200:201], v226 offset:0
    ds_read_b64_tr_b16 a[202:203], v226 offset:16384
    ds_read_b64_tr_b16 a[204:205], v227 offset:0
    ds_read_b64_tr_b16 a[206:207], v227 offset:16384
    ds_read_b64_tr_b16 a[208:209], v228 offset:0
    ds_read_b64_tr_b16 a[210:211], v228 offset:16384
    ds_read_b64_tr_b16 a[212:213], v229 offset:0
    ds_read_b64_tr_b16 a[214:215], v229 offset:16384
    ds_read_b64_tr_b16 a[216:217], v230 offset:0
    ds_read_b64_tr_b16 a[218:219], v230 offset:16384
    ds_read_b64_tr_b16 a[220:221], v231 offset:0
    ds_read_b64_tr_b16 a[222:223], v231 offset:16384
    ds_read_b64_tr_b16 a[224:225], v232 offset:0
    ds_read_b64_tr_b16 a[226:227], v232 offset:16384
    ds_read_b64_tr_b16 a[228:229], v233 offset:0
    ds_read_b64_tr_b16 a[230:231], v233 offset:16384
    ds_read_b64_tr_b16 a[232:233], v234 offset:0
    ds_read_b64_tr_b16 a[234:235], v234 offset:16384
    ds_read_b64_tr_b16 a[236:237], v235 offset:0
    ds_read_b64_tr_b16 a[238:239], v235 offset:16384
    ds_read_b64_tr_b16 a[240:241], v236 offset:0
    ds_read_b64_tr_b16 a[242:243], v236 offset:16384
    ds_read_b64_tr_b16 a[244:245], v237 offset:0
    ds_read_b64_tr_b16 a[246:247], v237 offset:16384
    ds_read_b64_tr_b16 a[248:249], v238 offset:0
    ds_read_b64_tr_b16 a[250:251], v238 offset:16384
    ds_read_b64_tr_b16 a[252:253], v239 offset:0
    ds_read_b64_tr_b16 a[254:255], v239 offset:16384
    s_mov_b32 s63, 0
    s_waitcnt vmcnt(0)
L_S:
    s_waitcnt lgkmcnt(0)
    s_barrier
    ds_read_b128 v[64:67], v24 offset:0
    ds_read_b128 v[68:71], v25 offset:0
    ds_read_b128 v[72:75], v26 offset:0
    ds_read_b128 v[76:79], v27 offset:0
    ds_read_b128 v[80:83], v24 offset:256
    ds_read_b128 v[84:87], v25 offset:256
    s_waitcnt lgkmcnt(5)
    v_mfma_f32_16x16x32_bf16 v[48:51], a[0:3], v[64:67], 0
    v_mfma_f32_16x16x32_bf16 v[52:55], a[64:67], v[64:67], 0
    global_load_dword v5, v244, s[14:15]
    ds_read_b128 v[88:91], v26 offset:256
    s_waitcnt lgkmcnt(5)
    v_mfma_f32_16x16x32_bf16 v[48:51], a[4:7], v[68:71], v[48:51]
    v_mfma_f32_16x16x32_bf16 v[52:55], a[68:71], v[68:71], v[52:55]
    ds_read_b128 v[92:95], v27 offset:256
    s_waitcnt lgkmcnt(4)
    v_mfma_f32_16x16x32_bf16 v[48:51], a[8:11], v[72:75], v[48:51]
    v_mfma_f32_16x16x32_bf16 v[52:55], a[72:75], v[72:75], v[52:55]
    ds_read_b128 v[64:67], v24 offset:512
    s_waitcnt lgkmcnt(4)
    v_mfma_f32_16x16x32_bf16 v[48:51], a[12:15], v[76:79], v[48:51]
    v_mfma_f32_16x16x32_bf16 v[52:55], a[76:79], v[76:79], v[52:55]
    ds_read_b128 v[68:71], v25 offset:512
    s_waitcnt lgkmcnt(4)
    v_mfma_f32_16x16x32_bf16 v[48:51], a[16:19], v[80:83], v[48:51]
    global_load_dword v5, v245, s[14:15]
    v_mfma_f32_16x16x32_bf16 v[52:55], a[80:83], v[80:83], v[52:55]
    ds_read_b128 v[72:75], v26 offset:512
    s_waitcnt lgkmcnt(4)
    v_mfma_f32_16x16x32_bf16 v[48:51], a[20:23], v[84:87], v[48:51]
    v_mfma_f32_16x16x32_bf16 v[52:55], a[84:87], v[84:87], v[52:55]
    ds_read_b128 v[76:79], v27 offset:512
    s_waitcnt lgkmcnt(4)
    v_mfma_f32_16x16x32_bf16 v[48:51], a[24:27], v[88:91], v[48:51]
    v_mfma_f32_16x16x32_bf16 v[52:55], a[88:91], v[88:91], v[52:55]
    ds_read_b128 v[80:83], v24 offset:768
    s_waitcnt lgkmcnt(4)
    v_mfma_f32_16x16x32_bf16 v[48:51], a[28:31], v[92:95], v[48:51]
    v_mfma_f32_16x16x32_bf16 v[52:55], a[92:95], v[92:95], v[52:55]
    global_load_dword v5, v246, s[14:15]
    ds_read_b128 v[84:87], v25 offset:768
    s_waitcnt lgkmcnt(4)
    v_mfma_f32_16x16x32_bf16 v[48:51], a[32:35], v[64:67], v[48:51]
    v_mfma_f32_16x16x32_bf16 v[52:55], a[96:99], v[64:67], v[52:55]
    ds_read_b128 v[88:91], v26 offset:768
    s_waitcnt lgkmcnt(4)
    v_mfma_f32_16x16x32_bf16 v[48:51], a[36:39], v[68:71], v[48:51]
    v_mfma_f32_16x16x32_bf16 v[52:55], a[100:103], v[68:71], v[52:55]
    ds_read_b128 v[92:95], v27 offset:768
    s_waitcnt lgkmcnt(4)
    v_mfma_f32_16x16x32_bf16 v[48:51], a[40:43], v[72:75], v[48:51]
    v_mfma_f32_16x16x32_bf16 v[52:55], a[104:107], v[72:75], v[52:55]
    ds_read_b128 v[64:67], v24 offset:16384
    s_waitcnt lgkmcnt(4)
    v_mfma_f32_16x16x32_bf16 v[48:51], a[44:47], v[76:79], v[48:51]
    global_load_dword v5, v247, s[14:15]
    v_mfma_f32_16x16x32_bf16 v[52:55], a[108:111], v[76:79], v[52:55]
    ds_read_b128 v[68:71], v25 offset:16384
    s_waitcnt lgkmcnt(4)
    v_mfma_f32_16x16x32_bf16 v[48:51], a[48:51], v[80:83], v[48:51]
    v_mfma_f32_16x16x32_bf16 v[52:55], a[112:115], v[80:83], v[52:55]
    ds_read_b128 v[72:75], v26 offset:16384
    s_waitcnt lgkmcnt(4)
    v_mfma_f32_16x16x32_bf16 v[48:51], a[52:55], v[84:87], v[48:51]
    v_mfma_f32_16x16x32_bf16 v[52:55], a[116:119], v[84:87], v[52:55]
    ds_read_b128 v[76:79], v27 offset:16384
    s_waitcnt lgkmcnt(4)
    v_mfma_f32_16x16x32_bf16 v[48:51], a[56:59], v[88:91], v[48:51]
    v_mfma_f32_16x16x32_bf16 v[52:55], a[120:123], v[88:91], v[52:55]
    ds_read_b128 v[80:83], v24 offset:16640
    s_waitcnt lgkmcnt(4)
    v_mfma_f32_16x16x32_bf16 v[48:51], a[60:63], v[92:95], v[48:51]
    v_mfma_f32_16x16x32_bf16 v[52:55], a[124:127], v[92:95], v[52:55]
    ds_read_b128 v[84:87], v25 offset:16640
    s_waitcnt lgkmcnt(4)
    v_mfma_f32_16x16x32_bf16 v[56:59], a[0:3], v[64:67], 0
    v_mfma_f32_16x16x32_bf16 v[60:63], a[64:67], v[64:67], 0
    s_nop 2
    v_max3_f32 v40, v48, v49, v50
    v_max3_f32 v248, v51, v52, v53
    ds_read_b128 v[88:91], v26 offset:16640
    s_waitcnt lgkmcnt(4)
    v_mfma_f32_16x16x32_bf16 v[56:59], a[4:7], v[68:71], v[56:59]
    v_max3_f32 v40, v40, v54, v55
    v_max_f32 v40, v40, v248
    v_mfma_f32_16x16x32_bf16 v[60:63], a[68:71], v[68:71], v[60:63]
    v_mov_b32 v248, v40
    ds_read_b128 v[92:95], v27 offset:16640
    s_waitcnt lgkmcnt(4)
    v_mfma_f32_16x16x32_bf16 v[56:59], a[8:11], v[72:75], v[56:59]
    v_permlane16_swap_b32 v40, v248
    v_mfma_f32_16x16x32_bf16 v[60:63], a[72:75], v[72:75], v[60:63]
    v_max_f32 v40, v40, v248
    v_mov_b32 v248, v40
    ds_read_b128 v[64:67], v24 offset:16896
    s_waitcnt lgkmcnt(4)
    v_mfma_f32_16x16x32_bf16 v[56:59], a[12:15], v[76:79], v[56:59]
    v_permlane32_swap_b32 v40, v248
    v_mfma_f32_16x16x32_bf16 v[60:63], a[76:79], v[76:79], v[60:63]
    v_max_f32 v40, v40, v248
    ds_write_b32 v30, v40 offset:0
    ds_read_b128 v[68:71], v25 offset:16896
    s_waitcnt lgkmcnt(5)
    v_mfma_f32_16x16x32_bf16 v[56:59], a[16:19], v[80:83], v[56:59]
    v_cvt_pk_bf16_f32 v32, v48, v49
    v_cvt_pk_bf16_f32 v33, v50, v51
    v_cvt_pk_bf16_f32 v34, v52, v53
    v_cvt_pk_bf16_f32 v35, v54, v55
    v_mfma_f32_16x16x32_bf16 v[60:63], a[80:83], v[80:83], v[60:63]
    v_lshlrev_b32 v48, 16, v32
    v_and_b32 v49, 0xffff0000, v32
    v_lshlrev_b32 v50, 16, v33
    v_and_b32 v51, 0xffff0000, v33
    ds_read_b128 v[72:75], v26 offset:16896
    s_waitcnt lgkmcnt(5)
    v_mfma_f32_16x16x32_bf16 v[56:59], a[20:23], v[84:87], v[56:59]
    v_lshlrev_b32 v52, 16, v34
    v_and_b32 v53, 0xffff0000, v34
    v_lshlrev_b32 v54, 16, v35
    v_and_b32 v55, 0xffff0000, v35
    v_mfma_f32_16x16x32_bf16 v[60:63], a[84:87], v[84:87], v[60:63]
    v_mul_f32 v48, s51, v48
    v_mul_f32 v49, s51, v49
    v_mul_f32 v50, s51, v50
    v_mul_f32 v51, s51, v51
    s_waitcnt lgkmcnt(2)
    s_barrier
    ds_read2st64_b32 v[248:249], v28 offset0:0 offset1:129
    ds_read2st64_b32 v[250:251], v29 offset0:0 offset1:129
    ds_read_b128 v[76:79], v27 offset:16896
    v_mfma_f32_16x16x32_bf16 v[56:59], a[24:27], v[88:91], v[56:59]
    v_mul_f32 v52, s51, v52
    v_mul_f32 v53, s51, v53
    v_mul_f32 v54, s51, v54
    v_mul_f32 v55, s51, v55
    v_mfma_f32_16x16x32_bf16 v[60:63], a[88:91], v[88:91], v[60:63]
    v_cvt_pk_bf16_f32 v32, v48, v49
    v_cvt_pk_bf16_f32 v33, v50, v51
    v_cvt_pk_bf16_f32 v34, v52, v53
    v_cvt_pk_bf16_f32 v35, v54, v55
    ds_read_b128 v[80:83], v24 offset:17152
    v_mfma_f32_16x16x32_bf16 v[56:59], a[28:31], v[92:95], v[56:59]
    v_lshlrev_b32 v48, 16, v32
    v_and_b32 v49, 0xffff0000, v32
    v_lshlrev_b32 v50, 16, v33
    v_and_b32 v51, 0xffff0000, v33
    v_mfma_f32_16x16x32_bf16 v[60:63], a[92:95], v[92:95], v[60:63]
    v_lshlrev_b32 v52, 16, v34
    v_and_b32 v53, 0xffff0000, v34
    v_lshlrev_b32 v54, 16, v35
    v_and_b32 v55, 0xffff0000, v35
    s_waitcnt lgkmcnt(2)
    v_max3_f32 v40, v248, v249, v250
    v_max_f32 v40, v40, v251
    v_cvt_pk_bf16_f32 v40, v40, v40
    ds_read_b128 v[84:87], v25 offset:17152
    v_mfma_f32_16x16x32_bf16 v[56:59], a[32:35], v[64:67], v[56:59]
    v_lshlrev_b32 v40, 16, v40
    v_mul_f32 v40, s51, v40
    v_cvt_pk_bf16_f32 v40, v40, v40
    v_mfma_f32_16x16x32_bf16 v[60:63], a[96:99], v[64:67], v[60:63]
    v_lshlrev_b32 v40, 16, v40
    v_mul_f32 v40, s50, v40
    v_fma_f32 v48, v48, s50, -v40
    ds_read_b128 v[88:91], v26 offset:17152
    v_mfma_f32_16x16x32_bf16 v[56:59], a[36:39], v[68:71], v[56:59]
    v_fma_f32 v49, v49, s50, -v40
    v_fma_f32 v50, v50, s50, -v40
    v_fma_f32 v51, v51, s50, -v40
    v_mfma_f32_16x16x32_bf16 v[60:63], a[100:103], v[68:71], v[60:63]
    v_fma_f32 v52, v52, s50, -v40
    v_fma_f32 v53, v53, s50, -v40
    v_fma_f32 v54, v54, s50, -v40
    ds_read_b128 v[92:95], v27 offset:17152
    s_waitcnt lgkmcnt(4)
    v_mfma_f32_16x16x32_bf16 v[56:59], a[40:43], v[72:75], v[56:59]
    v_fma_f32 v55, v55, s50, -v40
    v_exp_f32 v48, v48
    v_mfma_f32_16x16x32_bf16 v[60:63], a[104:107], v[72:75], v[60:63]
    v_exp_f32 v49, v49
    s_waitcnt lgkmcnt(3)
    v_mfma_f32_16x16x32_bf16 v[56:59], a[44:47], v[76:79], v[56:59]
    v_exp_f32 v50, v50
    v_mfma_f32_16x16x32_bf16 v[60:63], a[108:111], v[76:79], v[60:63]
    v_exp_f32 v51, v51
    s_waitcnt lgkmcnt(2)
    v_mfma_f32_16x16x32_bf16 v[56:59], a[48:51], v[80:83], v[56:59]
    v_exp_f32 v52, v52
    v_mfma_f32_16x16x32_bf16 v[60:63], a[112:115], v[80:83], v[60:63]
    v_exp_f32 v53, v53
    s_waitcnt lgkmcnt(1)
    v_mfma_f32_16x16x32_bf16 v[56:59], a[52:55], v[84:87], v[56:59]
    v_exp_f32 v54, v54
    v_mfma_f32_16x16x32_bf16 v[60:63], a[116:119], v[84:87], v[60:63]
    v_exp_f32 v55, v55
    v_cvt_pk_bf16_f32 v96, v48, v49
    s_waitcnt lgkmcnt(0)
    v_mfma_f32_16x16x32_bf16 v[56:59], a[56:59], v[88:91], v[56:59]
    v_cvt_pk_bf16_f32 v97, v50, v51
    v_cvt_pk_bf16_f32 v98, v52, v53
    v_cvt_pk_bf16_f32 v99, v54, v55
    v_mfma_f32_16x16x32_bf16 v[60:63], a[120:123], v[88:91], v[60:63]
    ds_write_b128 v200, v[96:99] offset:0
    v_mfma_f32_16x16x32_bf16 v[56:59], a[60:63], v[92:95], v[56:59]
    v_mfma_f32_16x16x32_bf16 v[60:63], a[124:127], v[92:95], v[60:63]
    v_mfma_f32_16x16x32_bf16 v[128:131], v[96:99], a[128:131], 0
    v_mfma_f32_16x16x32_bf16 v[132:135], v[96:99], a[132:135], 0
    v_mfma_f32_16x16x32_bf16 v[136:139], v[96:99], a[136:139], 0
    s_waitcnt lgkmcnt(0)
    s_barrier
    ds_read_b128 v[100:103], v201 offset:0
    ds_read_b128 v[104:107], v202 offset:0
    ds_read_b128 v[108:111], v203 offset:0
    v_cmp_u_f32 vcc, v40, v56
    s_cbranch_vccnz L_redo
L_go:
    v_mfma_f32_16x16x32_bf16 v[140:143], v[96:99], a[140:143], 0
    v_max3_f32 v41, v56, v57, v58
    v_max3_f32 v248, v59, v60, v61
    v_mfma_f32_16x16x32_bf16 v[144:147], v[96:99], a[144:147], 0
    v_max3_f32 v41, v41, v62, v63
    v_max_f32 v41, v41, v248
    v_mfma_f32_16x16x32_bf16 v[148:151], v[96:99], a[148:151], 0
    v_mov_b32 v248, v41
    v_mfma_f32_16x16x32_bf16 v[152:155], v[96:99], a[152:155], 0
    s_nop 0
    v_permlane16_swap_b32 v41, v248
    v_mfma_f32_16x16x32_bf16 v[156:159], v[96:99], a[156:159], 0
    v_max_f32 v41, v41, v248
    v_mov_b32 v248, v41
    s_waitcnt lgkmcnt(2)
    v_mfma_f32_16x16x32_bf16 v[128:131], v[100:103], a[160:163], v[128:131]
    v_permlane32_swap_b32 v41, v248
    v_mfma_f32_16x16x32_bf16 v[132:135], v[100:103], a[164:167], v[132:135]
    v_max_f32 v41, v41, v248
    ds_write_b32 v30, v41 offset:128
    v_mfma_f32_16x16x32_bf16 v[136:139], v[100:103], a[168:171], v[136:139]
    v_cvt_pk_bf16_f32 v32, v56, v57
    v_cvt_pk_bf16_f32 v33, v58, v59
    v_cvt_pk_bf16_f32 v34, v60, v61
    v_cvt_pk_bf16_f32 v35, v62, v63
    v_mfma_f32_16x16x32_bf16 v[140:143], v[100:103], a[172:175], v[140:143]
    v_lshlrev_b32 v56, 16, v32
    v_and_b32 v57, 0xffff0000, v32
    v_lshlrev_b32 v58, 16, v33
    v_and_b32 v59, 0xffff0000, v33
    v_mfma_f32_16x16x32_bf16 v[144:147], v[100:103], a[176:179], v[144:147]
    v_lshlrev_b32 v60, 16, v34
    v_and_b32 v61, 0xffff0000, v34
    v_lshlrev_b32 v62, 16, v35
    v_and_b32 v63, 0xffff0000, v35
    v_mfma_f32_16x16x32_bf16 v[148:151], v[100:103], a[180:183], v[148:151]
    v_mul_f32 v56, s51, v56
    v_mul_f32 v57, s51, v57
    v_mul_f32 v58, s51, v58
    v_mul_f32 v59, s51, v59
    s_waitcnt lgkmcnt(0)
    s_barrier
    ds_read2st64_b32 v[248:249], v42 offset0:0 offset1:129
    ds_read2st64_b32 v[250:251], v43 offset0:0 offset1:129
    v_mfma_f32_16x16x32_bf16 v[152:155], v[100:103], a[184:187], v[152:155]
    v_mul_f32 v60, s51, v60
    v_mul_f32 v61, s51, v61
    v_mul_f32 v62, s51, v62
    v_mul_f32 v63, s51, v63
    v_mfma_f32_16x16x32_bf16 v[156:159], v[100:103], a[188:191], v[156:159]
    v_cvt_pk_bf16_f32 v32, v56, v57
    v_cvt_pk_bf16_f32 v33, v58, v59
    v_cvt_pk_bf16_f32 v34, v60, v61
    v_cvt_pk_bf16_f32 v35, v62, v63
    v_mfma_f32_16x16x32_bf16 v[128:131], v[104:107], a[192:195], v[128:131]
    v_lshlrev_b32 v56, 16, v32
    v_and_b32 v57, 0xffff0000, v32
    v_lshlrev_b32 v58, 16, v33
    v_and_b32 v59, 0xffff0000, v33
    v_mfma_f32_16x16x32_bf16 v[132:135], v[104:107], a[196:199], v[132:135]
    v_lshlrev_b32 v60, 16, v34
    v_and_b32 v61, 0xffff0000, v34
    v_lshlrev_b32 v62, 16, v35
    v_and_b32 v63, 0xffff0000, v35
    s_waitcnt lgkmcnt(0)
    v_max3_f32 v41, v248, v249, v250
    v_max_f32 v41, v41, v251
    v_cvt_pk_bf16_f32 v41, v41, v41
    v_mfma_f32_16x16x32_bf16 v[136:139], v[104:107], a[200:203], v[136:139]
    v_lshlrev_b32 v41, 16, v41
    v_mul_f32 v41, s51, v41
    v_cvt_pk_bf16_f32 v41, v41, v41
    v_mfma_f32_16x16x32_bf16 v[140:143], v[104:107], a[204:207], v[140:143]
    v_lshlrev_b32 v41, 16, v41
    v_mul_f32 v41, s50, v41
    v_fma_f32 v56, v56, s50, -v41
    v_mfma_f32_16x16x32_bf16 v[144:147], v[104:107], a[208:211], v[144:147]
    v_fma_f32 v57, v57, s50, -v41
    v_fma_f32 v58, v58, s50, -v41
    v_fma_f32 v59, v59, s50, -v41
    v_mfma_f32_16x16x32_bf16 v[148:151], v[104:107], a[212:215], v[148:151]
    v_fma_f32 v60, v60, s50, -v41
    v_fma_f32 v61, v61, s50, -v41
    v_fma_f32 v62, v62, s50, -v41
    v_mfma_f32_16x16x32_bf16 v[152:155], v[104:107], a[216:219], v[152:155]
    v_fma_f32 v63, v63, s50, -v41
    v_exp_f32 v56, v56
    v_mfma_f32_16x16x32_bf16 v[156:159], v[104:107], a[220:223], v[156:159]
    v_exp_f32 v57, v57
    v_mfma_f32_16x16x32_bf16 v[128:131], v[108:111], a[224:227], v[128:131]
    v_exp_f32 v58, v58
    v_mfma_f32_16x16x32_bf16 v[132:135], v[108:111], a[228:231], v[132:135]
    v_exp_f32 v59, v59
    v_mfma_f32_16x16x32_bf16 v[136:139], v[108:111], a[232:235], v[136:139]
    v_exp_f32 v60, v60
    v_mfma_f32_16x16x32_bf16 v[140:143], v[108:111], a[236:239], v[140:143]
    v_exp_f32 v61, v61
    v_mfma_f32_16x16x32_bf16 v[144:147], v[108:111], a[240:243], v[144:147]
    v_exp_f32 v62, v62
    v_mfma_f32_16x16x32_bf16 v[148:151], v[108:111], a[244:247], v[148:151]
    v_exp_f32 v63, v63
    v_cvt_pk_bf16_f32 v112, v56, v57
    v_mfma_f32_16x16x32_bf16 v[152:155], v[108:111], a[248:251], v[152:155]
    v_cvt_pk_bf16_f32 v113, v58, v59
    v_cvt_pk_bf16_f32 v114, v60, v61
    v_cvt_pk_bf16_f32 v115, v62, v63
    v_mfma_f32_16x16x32_bf16 v[156:159], v[108:111], a[252:255], v[156:159]
    ds_write_b128 v200, v[112:115] offset:4096
    v_mfma_f32_16x16x32_bf16 v[160:163], v[112:115], a[128:131], 0
    v_mfma_f32_16x16x32_bf16 v[164:167], v[112:115], a[132:135], 0
    v_mfma_f32_16x16x32_bf16 v[168:171], v[112:115], a[136:139], 0
    v_mfma_f32_16x16x32_bf16 v[172:175], v[112:115], a[140:143], 0
    v_cvt_pk_bf16_f32 v64, v128, v132
    v_cvt_pk_bf16_f32 v65, v136, v140
    v_mfma_f32_16x16x32_bf16 v[176:179], v[112:115], a[144:147], 0
    s_waitcnt lgkmcnt(0)
    s_barrier
    ds_read_b128 v[116:119], v201 offset:4096
    ds_read_b128 v[120:123], v202 offset:4096
    ds_read_b128 v[124:127], v203 offset:4096
    v_cvt_pk_bf16_f32 v66, v144, v148
    v_cvt_pk_bf16_f32 v67, v152, v156
    s_cmp_lg_u32 s52, 0
    s_cbranch_scc1 Lnl_33
    v_mfma_f32_16x16x32_bf16 v[32:35], v[96:99], v[36:39], 0
    v_mfma_f32_16x16x32_bf16 v[32:35], v[100:103], v[36:39], v[32:35]
    v_mfma_f32_16x16x32_bf16 v[32:35], v[104:107], v[36:39], v[32:35]
    v_mfma_f32_16x16x32_bf16 v[32:35], v[108:111], v[36:39], v[32:35]
Lnl_33:
    v_mfma_f32_16x16x32_bf16 v[180:183], v[112:115], a[148:151], 0
    v_bfi_b32 v64, v22, s44, v64
    v_bfi_b32 v65, v22, s45, v65
    v_mfma_f32_16x16x32_bf16 v[184:187], v[112:115], a[152:155], 0
    v_bfi_b32 v66, v22, s46, v66
    v_bfi_b32 v67, v22, s47, v67
    v_mfma_f32_16x16x32_bf16 v[188:191], v[112:115], a[156:159], 0
    s_add_u32 s61, s65, 0
    buffer_store_dwordx4 v[64:67], v20, s[32:35], s61 offen sc1
    s_waitcnt lgkmcnt(2)
    v_mfma_f32_16x16x32_bf16 v[160:163], v[116:119], a[160:163], v[160:163]
    s_cmp_lg_u32 s52, 0
    s_cbranch_scc1 Lns_34
    s_nop 3
    v_cndmask_b32 v32, v32, v33, s[72:73]
    v_cndmask_b32 v34, v34, v35, s[72:73]
    v_mov_b32 v44, v40
    v_cndmask_b32 v45, v32, v34, s[0:1]
    s_and_b32 exec_lo, s16, 0xf0000f
    s_and_b32 exec_hi, s16, 0xf0000f00
    buffer_store_dwordx4 v[44:47], v31, s[32:35], s70 offen offset:0 sc1
    s_mov_b64 exec, s[16:17]
Lns_34:
    v_mfma_f32_16x16x32_bf16 v[164:167], v[116:119], a[164:167], v[164:167]
    v_mfma_f32_16x16x32_bf16 v[168:171], v[116:119], a[168:171], v[168:171]
    v_cvt_pk_bf16_f32 v68, v129, v133
    v_cvt_pk_bf16_f32 v69, v137, v141
    v_mfma_f32_16x16x32_bf16 v[172:175], v[116:119], a[172:175], v[172:175]
    v_cvt_pk_bf16_f32 v70, v145, v149
    v_cvt_pk_bf16_f32 v71, v153, v157
    s_waitcnt lgkmcnt(0)
    s_cmp_lg_u32 s52, 1
    s_cbranch_scc1 Lnl_35
    v_mfma_f32_16x16x32_bf16 v[32:35], v[112:115], v[36:39], 0
    v_mfma_f32_16x16x32_bf16 v[32:35], v[116:119], v[36:39], v[32:35]
    v_mfma_f32_16x16x32_bf16 v[32:35], v[120:123], v[36:39], v[32:35]
    v_mfma_f32_16x16x32_bf16 v[32:35], v[124:127], v[36:39], v[32:35]
Lnl_35:
    v_mfma_f32_16x16x32_bf16 v[176:179], v[116:119], a[176:179], v[176:179]
    v_bfi_b32 v68, v22, s44, v68
    v_bfi_b32 v69, v22, s45, v69
    v_mfma_f32_16x16x32_bf16 v[180:183], v[116:119], a[180:183], v[180:183]
    v_bfi_b32 v70, v22, s46, v70
    v_bfi_b32 v71, v22, s47, v71
    v_mfma_f32_16x16x32_bf16 v[184:187], v[116:119], a[184:187], v[184:187]
    s_add_u32 s61, s65, 32768
    buffer_store_dwordx4 v[68:71], v20, s[32:35], s61 offen sc1
    v_mfma_f32_16x16x32_bf16 v[188:191], v[116:119], a[188:191], v[188:191]
    s_cmp_lg_u32 s52, 1
    s_cbranch_scc1 Lns_36
    s_nop 3
    v_cndmask_b32 v32, v32, v33, s[72:73]
    v_cndmask_b32 v34, v34, v35, s[72:73]
    v_mov_b32 v44, v41
    v_cndmask_b32 v45, v32, v34, s[0:1]
    s_and_b32 exec_lo, s16, 0xf0000f
    s_and_b32 exec_hi, s16, 0xf0000f00
    buffer_store_dwordx4 v[44:47], v31, s[32:35], s70 offen offset:256 sc1
    s_mov_b64 exec, s[16:17]
Lns_36:
    v_mfma_f32_16x16x32_bf16 v[160:163], v[120:123], a[192:195], v[160:163]
    v_mfma_f32_16x16x32_bf16 v[164:167], v[120:123], a[196:199], v[164:167]
    v_cvt_pk_bf16_f32 v72, v130, v134
    v_cvt_pk_bf16_f32 v73, v138, v142
    v_mfma_f32_16x16x32_bf16 v[168:171], v[120:123], a[200:203], v[168:171]
    v_cvt_pk_bf16_f32 v74, v146, v150
    v_cvt_pk_bf16_f32 v75, v154, v158
    v_mfma_f32_16x16x32_bf16 v[172:175], v[120:123], a[204:207], v[172:175]
    v_bfi_b32 v72, v22, s44, v72
    v_bfi_b32 v73, v22, s45, v73
    v_mfma_f32_16x16x32_bf16 v[176:179], v[120:123], a[208:211], v[176:179]
    v_bfi_b32 v74, v22, s46, v74
    v_bfi_b32 v75, v22, s47, v75
    v_mfma_f32_16x16x32_bf16 v[180:183], v[120:123], a[212:215], v[180:183]
    s_add_u32 s61, s65, 65536
    buffer_store_dwordx4 v[72:75], v20, s[32:35], s61 offen sc1
    v_mfma_f32_16x16x32_bf16 v[184:187], v[120:123], a[216:219], v[184:187]
    v_mfma_f32_16x16x32_bf16 v[188:191], v[120:123], a[220:223], v[188:191]
    v_mfma_f32_16x16x32_bf16 v[160:163], v[124:127], a[224:227], v[160:163]
    v_cvt_pk_bf16_f32 v76, v131, v135
    v_cvt_pk_bf16_f32 v77, v139, v143
    v_mfma_f32_16x16x32_bf16 v[164:167], v[124:127], a[228:231], v[164:167]
    v_cvt_pk_bf16_f32 v78, v147, v151
    v_cvt_pk_bf16_f32 v79, v155, v159
    v_mfma_f32_16x16x32_bf16 v[168:171], v[124:127], a[232:235], v[168:171]
    v_bfi_b32 v76, v22, s44, v76
    v_bfi_b32 v77, v22, s45, v77
    v_mfma_f32_16x16x32_bf16 v[172:175], v[124:127], a[236:239], v[172:175]
    v_bfi_b32 v78, v22, s46, v78
    v_bfi_b32 v79, v22, s47, v79
    v_mfma_f32_16x16x32_bf16 v[176:179], v[124:127], a[240:243], v[176:179]
    s_add_u32 s61, s65, 98304
    buffer_store_dwordx4 v[76:79], v20, s[32:35], s61 offen sc1
    v_mfma_f32_16x16x32_bf16 v[180:183], v[124:127], a[244:247], v[180:183]
    v_mfma_f32_16x16x32_bf16 v[184:187], v[124:127], a[248:251], v[184:187]
    v_mfma_f32_16x16x32_bf16 v[188:191], v[124:127], a[252:255], v[188:191]
    v_cvt_pk_bf16_f32 v80, v160, v164
    v_cvt_pk_bf16_f32 v81, v168, v172
    s_nop 3
    v_cvt_pk_bf16_f32 v82, v176, v180
    s_nop 0
    v_cvt_pk_bf16_f32 v83, v184, v188
    v_bfi_b32 v80, v22, s44, v80
    v_bfi_b32 v81, v22, s45, v81
    v_bfi_b32 v82, v22, s46, v82
    v_bfi_b32 v83, v22, s47, v83
    s_add_u32 s61, s65, 524288
    buffer_store_dwordx4 v[80:83], v20, s[32:35], s61 offen sc1
    v_cvt_pk_bf16_f32 v84, v161, v165
    v_cvt_pk_bf16_f32 v85, v169, v173
    v_cvt_pk_bf16_f32 v86, v177, v181
    v_cvt_pk_bf16_f32 v87, v185, v189
    v_bfi_b32 v84, v22, s44, v84
    v_bfi_b32 v85, v22, s45, v85
    v_bfi_b32 v86, v22, s46, v86
    v_bfi_b32 v87, v22, s47, v87
    s_add_u32 s61, s65, 557056
    buffer_store_dwordx4 v[84:87], v20, s[32:35], s61 offen sc1
    v_cvt_pk_bf16_f32 v88, v162, v166
    v_cvt_pk_bf16_f32 v89, v170, v174
    v_cvt_pk_bf16_f32 v90, v178, v182
    v_cvt_pk_bf16_f32 v91, v186, v190
    v_bfi_b32 v88, v22, s44, v88
    v_bfi_b32 v89, v22, s45, v89
    v_bfi_b32 v90, v22, s46, v90
    v_bfi_b32 v91, v22, s47, v91
    s_add_u32 s61, s65, 589824
    buffer_store_dwordx4 v[88:91], v20, s[32:35], s61 offen sc1
    v_cvt_pk_bf16_f32 v92, v163, v167
    v_cvt_pk_bf16_f32 v93, v171, v175
    v_cvt_pk_bf16_f32 v94, v179, v183
    v_cvt_pk_bf16_f32 v95, v187, v191
    v_bfi_b32 v92, v22, s44, v92
    v_bfi_b32 v93, v22, s45, v93
    v_bfi_b32 v94, v22, s46, v94
    v_bfi_b32 v95, v22, s47, v95
    s_add_u32 s61, s65, 622592
    buffer_store_dwordx4 v[92:95], v20, s[32:35], s61 offen sc1
    s_barrier
    s_cmp_lt_u32 s67, 56
    s_cbranch_scc1 L_ffn
    s_cmp_lt_u32 s58, 8
    s_cbranch_scc1 L_fin
    s_lshr_b32 s56, s53, 1
    s_and_b32 s60, s53, 1
    s_lshl_b32 s60, s60, 3
    s_add_u32 s57, s60, s58
    s_sub_u32 s57, s57, 8
    s_mov_b32 s36, s14
    s_mov_b32 s37, s15
    s_mov_b32 s38, 4194304
    s_mov_b32 s39, 0x00020000
    v_lshrrev_b32 v12, 2, v1
    v_lshlrev_b32 v12, 10, v12
    v_bfe_u32 v13, v1, 1, 1
    v_xor_b32 v13, v13, v11
    v_lshl_add_u32 v12, v13, 5, v12
    v_and_b32 v13, 1, v1
    v_lshl_add_u32 v12, v13, 4, v12
    s_lshl_b32 s61, s56, 2
    s_add_u32 s61, s61, s52
    s_lshl_b32 s59, s61, 8
    s_lshl_b32 s61, s59, 10
    s_lshl_b32 s62, s57, 6
    s_add_u32 s61, s61, s62
    s_lshl_b32 s62, s52, 14
    s_mov_b32 m0, s62
    s_add_u32 s62, s62, 1024
    buffer_load_dwordx4 v12, s[36:39], s61 offen  lds
    s_add_u32 s61, s61, 16384
    s_mov_b32 m0, s62
    s_add_u32 s62, s62, 1024
    buffer_load_dwordx4 v12, s[36:39], s61 offen  lds
    s_add_u32 s61, s61, 16384
    s_mov_b32 m0, s62
    s_add_u32 s62, s62, 1024
    buffer_load_dwordx4 v12, s[36:39], s61 offen  lds
    s_add_u32 s61, s61, 16384
    s_mov_b32 m0, s62
    s_add_u32 s62, s62, 1024
    buffer_load_dwordx4 v12, s[36:39], s61 offen  lds
    s_add_u32 s61, s61, 16384
    s_mov_b32 m0, s62
    s_add_u32 s62, s62, 1024
    buffer_load_dwordx4 v12, s[36:39], s61 offen  lds
    s_add_u32 s61, s61, 16384
    s_mov_b32 m0, s62
    s_add_u32 s62, s62, 1024
    buffer_load_dwordx4 v12, s[36:39], s61 offen  lds
    s_add_u32 s61, s61, 16384
    s_mov_b32 m0, s62
    s_add_u32 s62, s62, 1024
    buffer_load_dwordx4 v12, s[36:39], s61 offen  lds
    s_add_u32 s61, s61, 16384
    s_mov_b32 m0, s62
    s_add_u32 s62, s62, 1024
    buffer_load_dwordx4 v12, s[36:39], s61 offen  lds
    s_add_u32 s61, s61, 16384
    s_mov_b32 m0, s62
    s_add_u32 s62, s62, 1024
    buffer_load_dwordx4 v12, s[36:39], s61 offen  lds
    s_add_u32 s61, s61, 16384
    s_mov_b32 m0, s62
    s_add_u32 s62, s62, 1024
    buffer_load_dwordx4 v12, s[36:39], s61 offen  lds
    s_add_u32 s61, s61, 16384
    s_mov_b32 m0, s62
    s_add_u32 s62, s62, 1024
    buffer_load_dwordx4 v12, s[36:39], s61 offen  lds
    s_add_u32 s61, s61, 16384
    s_mov_b32 m0, s62
    s_add_u32 s62, s62, 1024
    buffer_load_dwordx4 v12, s[36:39], s61 offen  lds
    s_add_u32 s61, s61, 16384
    s_mov_b32 m0, s62
    s_add_u32 s62, s62, 1024
    buffer_load_dwordx4 v12, s[36:39], s61 offen  lds
    s_add_u32 s61, s61, 16384
    s_mov_b32 m0, s62
    s_add_u32 s62, s62, 1024
    buffer_load_dwordx4 v12, s[36:39], s61 offen  lds
    s_add_u32 s61, s61, 16384
    s_mov_b32 m0, s62
    s_add_u32 s62, s62, 1024
    buffer_load_dwordx4 v12, s[36:39], s61 offen  lds
    s_add_u32 s61, s61, 16384
    s_mov_b32 m0, s62
    s_add_u32 s62, s62, 1024
    buffer_load_dwordx4 v12, s[36:39], s61 offen  lds
    s_add_u32 s61, s61, 16384
    v_bfe_u32 v12, v1, 2, 2
    v_lshl_add_u32 v12, v2, 3, v12
    v_lshlrev_b32 v12, 6, v12
    v_and_b32 v13, 3, v1
    v_lshl_add_u32 v12, v13, 3, v12
    v_and_b32 v13, 1, v2
    v_lshl_add_u32 v12, v13, 5, v12
    s_lshl_b32 s61, s52, 14
    v_add_u32 v12, s61, v12
    v_xor_b32 v13, 32, v12
    v_and_b32 v14, 3, v3
    v_lshlrev_b32 v14, 13, v14
    v_lshrrev_b32 v15, 2, v3
    v_lshl_add_u32 v14, v15, 6, v14
    v_lshl_add_u32 v14, v2, 4, v14
    s_lshl_b32 s64, s59, 1
    s_add_u32 s64, s64, 393216
    v_lshlrev_b32 v20, 7, v3
    v_lshl_add_u32 v20, v2, 4, v20
    s_lshl_b32 s61, s52, 9
    s_add_u32 s61, s61, 131072
    v_add_u32 v20, s61, v20
    v_add_u32 v21, 131072, v8
    v_lshlrev_b32 v22, 3, v1
    s_lshl_b32 s61, s56, 12
    s_lshl_b32 s62, s57, 8
    s_add_u32 s65, s61, s62
    s_add_u32 s65, s65, 425984
    s_waitcnt vmcnt(0)
    ds_read_b64_tr_b16 a[0:1], v12 offset:0
    ds_read_b64_tr_b16 a[2:3], v12 offset:256
    ds_read_b64_tr_b16 a[4:5], v13 offset:0
    ds_read_b64_tr_b16 a[6:7], v13 offset:256
    ds_read_b64_tr_b16 a[8:9], v12 offset:2048
    ds_read_b64_tr_b16 a[10:11], v12 offset:2304
    ds_read_b64_tr_b16 a[12:13], v13 offset:2048
    ds_read_b64_tr_b16 a[14:15], v13 offset:2304
    ds_read_b64_tr_b16 a[16:17], v12 offset:4096
    ds_read_b64_tr_b16 a[18:19], v12 offset:4352
    ds_read_b64_tr_b16 a[20:21], v13 offset:4096
    ds_read_b64_tr_b16 a[22:23], v13 offset:4352
    ds_read_b64_tr_b16 a[24:25], v12 offset:6144
    ds_read_b64_tr_b16 a[26:27], v12 offset:6400
    ds_read_b64_tr_b16 a[28:29], v13 offset:6144
    ds_read_b64_tr_b16 a[30:31], v13 offset:6400
    ds_read_b64_tr_b16 a[32:33], v12 offset:8192
    ds_read_b64_tr_b16 a[34:35], v12 offset:8448
    ds_read_b64_tr_b16 a[36:37], v13 offset:8192
    ds_read_b64_tr_b16 a[38:39], v13 offset:8448
    ds_read_b64_tr_b16 a[40:41], v12 offset:10240
    ds_read_b64_tr_b16 a[42:43], v12 offset:10496
    ds_read_b64_tr_b16 a[44:45], v13 offset:10240
    ds_read_b64_tr_b16 a[46:47], v13 offset:10496
    ds_read_b64_tr_b16 a[48:49], v12 offset:12288
    ds_read_b64_tr_b16 a[50:51], v12 offset:12544
    ds_read_b64_tr_b16 a[52:53], v13 offset:12288
    ds_read_b64_tr_b16 a[54:55], v13 offset:12544
    ds_read_b64_tr_b16 a[56:57], v12 offset:14336
    ds_read_b64_tr_b16 a[58:59], v12 offset:14592
    ds_read_b64_tr_b16 a[60:61], v13 offset:14336
    ds_read_b64_tr_b16 a[62:63], v13 offset:14592
    s_waitcnt lgkmcnt(0)
    s_and_b32 s71, s57, 7
    s_or_b32 s71, s71, s52
    s_lshl_b32 s70, s53, 7
    s_add_u32 s70, s70, 180224
    v_mov_b32 v24, s55
    s_mov_b32 s63, 0
Lp_37:
    buffer_load_dwordx4 v[64:67], v14, s[32:35], s64 offen sc1
    buffer_load_dwordx4 v[80:83], v14, s[32:35], s64 offen offset:256 sc1
Lpc_39:
    s_waitcnt vmcnt(0)
    v_max3_u32 v15, v64, v65, v66
    v_max3_u32 v15, v15, v67, v80
    v_max3_u32 v15, v15, v81, v82
    v_max_u32 v15, v15, v83
    v_cmp_eq_u32 vcc, -1, v15
    s_cbranch_vccz Lpd_38
    s_add_u32 s63, s63, 1
    s_cmp_lt_u32 s63, 30000
    s_cbranch_scc1 Lp_37
Lpd_38:
    s_cmp_lg_u32 s71, 0
    s_cbranch_scc1 Lh5_40
    s_and_b32 exec_lo, s16, 0x1
    s_mov_b32 exec_hi, 0
    buffer_store_dword v24, v4, s[32:35], s70 offen sc1
    s_mov_b64 exec, s[16:17]
Lh5_40:
    v_mfma_f32_16x16x32_bf16 v[44:47], a[0:3], v[64:67], 0
    v_mov_b32_dpp v68, v64 row_shl:4 row_mask:0xf bank_mask:0xf
    v_mov_b32_dpp v69, v65 row_shl:4 row_mask:0xf bank_mask:0xf
    v_mfma_f32_16x16x32_bf16 v[48:51], a[4:7], v[64:67], 0
    v_mov_b32_dpp v70, v66 row_shl:4 row_mask:0xf bank_mask:0xf
    v_mov_b32_dpp v71, v67 row_shl:4 row_mask:0xf bank_mask:0xf
    v_mfma_f32_16x16x32_bf16 v[52:55], a[32:35], v[80:83], 0
    v_mov_b32_dpp v84, v80 row_shl:4 row_mask:0xf bank_mask:0xf
    v_mov_b32_dpp v85, v81 row_shl:4 row_mask:0xf bank_mask:0xf
    v_mfma_f32_16x16x32_bf16 v[56:59], a[36:39], v[80:83], 0
    v_mov_b32_dpp v86, v82 row_shl:4 row_mask:0xf bank_mask:0xf
    v_mov_b32_dpp v87, v83 row_shl:4 row_mask:0xf bank_mask:0xf
    v_mfma_f32_16x16x32_bf16 v[44:47], a[8:11], v[68:71], v[44:47]
    v_mov_b32_dpp v72, v64 row_shl:8 row_mask:0xf bank_mask:0xf
    v_mov_b32_dpp v73, v65 row_shl:8 row_mask:0xf bank_mask:0xf
    v_mfma_f32_16x16x32_bf16 v[48:51], a[12:15], v[68:71], v[48:51]
    v_mov_b32_dpp v74, v66 row_shl:8 row_mask:0xf bank_mask:0xf
    v_mov_b32_dpp v75, v67 row_shl:8 row_mask:0xf bank_mask:0xf
    v_mfma_f32_16x16x32_bf16 v[52:55], a[40:43], v[84:87], v[52:55]
    v_mov_b32_dpp v88, v80 row_shl:8 row_mask:0xf bank_mask:0xf
    v_mov_b32_dpp v89, v81 row_shl:8 row_mask:0xf bank_mask:0xf
    v_mfma_f32_16x16x32_bf16 v[56:59], a[44:47], v[84:87], v[56:59]
    v_mov_b32_dpp v90, v82 row_shl:8 row_mask:0xf bank_mask:0xf
    v_mov_b32_dpp v91, v83 row_shl:8 row_mask:0xf bank_mask:0xf
    v_mfma_f32_16x16x32_bf16 v[44:47], a[16:19], v[72:75], v[44:47]
    v_mov_b32_dpp v76, v64 row_shl:12 row_mask:0xf bank_mask:0xf
    v_mov_b32_dpp v77, v65 row_shl:12 row_mask:0xf bank_mask:0xf
    v_mfma_f32_16x16x32_bf16 v[48:51], a[20:23], v[72:75], v[48:51]
    v_mov_b32_dpp v78, v66 row_shl:12 row_mask:0xf bank_mask:0xf
    v_mov_b32_dpp v79, v67 row_shl:12 row_mask:0xf bank_mask:0xf
    v_mfma_f32_16x16x32_bf16 v[52:55], a[48:51], v[88:91], v[52:55]
    v_mov_b32_dpp v92, v80 row_shl:12 row_mask:0xf bank_mask:0xf
    v_mov_b32_dpp v93, v81 row_shl:12 row_mask:0xf bank_mask:0xf
    v_mfma_f32_16x16x32_bf16 v[56:59], a[52:55], v[88:91], v[56:59]
    v_mov_b32_dpp v94, v82 row_shl:12 row_mask:0xf bank_mask:0xf
    v_mov_b32_dpp v95, v83 row_shl:12 row_mask:0xf bank_mask:0xf
    v_mfma_f32_16x16x32_bf16 v[44:47], a[24:27], v[76:79], v[44:47]
    v_mfma_f32_16x16x32_bf16 v[48:51], a[28:31], v[76:79], v[48:51]
    v_mfma_f32_16x16x32_bf16 v[52:55], a[56:59], v[92:95], v[52:55]
    v_mfma_f32_16x16x32_bf16 v[56:59], a[60:63], v[92:95], v[56:59]
    s_nop 6
    v_pk_add_f32 v[44:45], v[44:45], v[52:53]
    v_pk_add_f32 v[46:47], v[46:47], v[54:55]
    v_pk_add_f32 v[48:49], v[48:49], v[56:57]
    v_pk_add_f32 v[50:51], v[50:51], v[58:59]
    s_and_b32 exec_lo, s16, 0xf000f
    s_and_b32 exec_hi, s16, 0xf000f
    ds_write_b128 v20, v[44:47]
    ds_write_b128 v20, v[48:51] offset:64
    s_mov_b64 exec, s[16:17]
    s_waitcnt lgkmcnt(0)
    s_barrier
    s_cmp_lg_u32 s52, 0
    s_cbranch_scc1 L_opend
    s_mov_b32 exec_lo, s16
    s_mov_b32 exec_hi, 0
    ds_read_b128 v[64:67], v21 offset:0
    ds_read_b128 v[68:71], v21 offset:512
    ds_read_b128 v[72:75], v21 offset:1024
    ds_read_b128 v[76:79], v21 offset:1536
    s_waitcnt lgkmcnt(0)
    v_pk_add_f32 v[64:65], v[64:65], v[68:69]
    v_pk_add_f32 v[72:73], v[72:73], v[76:77]
    v_pk_add_f32 v[66:67], v[66:67], v[70:71]
    v_pk_add_f32 v[74:75], v[74:75], v[78:79]
    v_pk_add_f32 v[64:65], v[64:65], v[72:73]
    v_pk_add_f32 v[66:67], v[66:67], v[74:75]
    v_cvt_pk_bf16_f32 v64, v64, v65
    v_cvt_pk_bf16_f32 v65, v66, v67
    buffer_store_dwordx2 v[64:65], v22, s[32:35], s65 offen sc1
    s_mov_b64 exec, s[16:17]
L_opend:
    s_branch L_fin
L_redo:
    s_add_u32 s63, s63, 1
    s_cmp_ge_u32 s63, 7500
    s_cbranch_scc1 L_go
    s_waitcnt lgkmcnt(0)
    s_barrier
    s_mov_b32 s61, s64
    s_lshl_b32 s60, s52, 13
    s_add_u32 s60, s60, 131072
    s_mov_b32 m0, s60
    s_add_u32 s60, s60, 1024
    buffer_load_dwordx4 v192, s[32:35], s61 offen sc1 lds
    s_add_u32 s61, s61, 1024
    s_mov_b32 m0, s60
    s_add_u32 s60, s60, 1024
    buffer_load_dwordx4 v193, s[32:35], s61 offen sc1 lds
    s_add_u32 s61, s61, 1024
    s_mov_b32 m0, s60
    s_add_u32 s60, s60, 1024
    buffer_load_dwordx4 v194, s[32:35], s61 offen sc1 lds
    s_add_u32 s61, s61, 1024
    s_mov_b32 m0, s60
    s_add_u32 s60, s60, 1024
    buffer_load_dwordx4 v195, s[32:35], s61 offen sc1 lds
    s_add_u32 s61, s61, 1024
    s_mov_b32 m0, s60
    s_add_u32 s60, s60, 1024
    buffer_load_dwordx4 v196, s[32:35], s61 offen sc1 lds
    s_add_u32 s61, s61, 1024
    s_mov_b32 m0, s60
    s_add_u32 s60, s60, 1024
    buffer_load_dwordx4 v197, s[32:35], s61 offen sc1 lds
    s_add_u32 s61, s61, 1024
    s_mov_b32 m0, s60
    s_add_u32 s60, s60, 1024
    buffer_load_dwordx4 v198, s[32:35], s61 offen sc1 lds
    s_add_u32 s61, s61, 1024
    s_mov_b32 m0, s60
    s_add_u32 s60, s60, 1024
    buffer_load_dwordx4 v199, s[32:35], s61 offen sc1 lds
    s_add_u32 s61, s61, 1024
    s_lshl_b32 s61, s52, 15
    s_mov_b32 m0, s61
    s_nop 0
    buffer_load_dwordx4 v8, s[36:39], s61 offen  lds
    s_waitcnt vmcnt(0)
    s_branch L_S
L_ffn:
    s_and_b32 s60, s67, 1
    s_lshl_b32 s60, s60, 8
    v_add_u32 v12, s60, v0
    v_mul_u32_u24 v12, 3584, v12
    s_lshr_b32 s60, s67, 1
    s_lshl_b32 s60, s60, 7
    v_add_u32 v12, s60, v12
    global_load_dword v5, v12, s[18:19]
    global_load_dword v5, v12, s[20:21]
    s_mov_b32 s36, s18
    s_mov_b32 s37, s19
    s_mov_b32 s38, 1835008
    s_mov_b32 s39, 0x00020000
    s_mov_b32 s40, s20
    s_mov_b32 s41, s21
    s_mov_b32 s42, 1835008
    s_mov_b32 s43, 0x00020000
    s_mov_b32 s44, s22
    s_mov_b32 s45, s23
    s_mov_b32 s46, 1835008
    s_mov_b32 s47, 0x00020000
    s_mov_b32 s48, s4
    s_mov_b32 s49, s5
    s_mov_b32 s50, 4096
    s_mov_b32 s51, 0x00020000
    s_lshl_b32 s61, s67, 15
    s_lshl_b32 s62, s52, 13
    s_add_u32 s61, s61, s62
    s_add_u32 s62, s62, 65536
    s_and_b32 s60, s52, 1
    s_lshl_b32 s60, s60, 7
    v_xor_b32 v30, s60, v8
    s_mov_b32 m0, s62
    s_add_u32 s62, s62, 1024
    v_xor_b32 v31, 0, v30
    buffer_load_dwordx4 v31, s[44:47], s61 offen nt lds
    s_add_u32 s61, s61, 1024
    s_mov_b32 m0, s62
    s_add_u32 s62, s62, 1024
    v_xor_b32 v31, 32, v30
    buffer_load_dwordx4 v31, s[44:47], s61 offen nt lds
    s_add_u32 s61, s61, 1024
    s_mov_b32 m0, s62
    s_add_u32 s62, s62, 1024
    v_xor_b32 v31, 64, v30
    buffer_load_dwordx4 v31, s[44:47], s61 offen nt lds
    s_add_u32 s61, s61, 1024
    s_mov_b32 m0, s62
    s_add_u32 s62, s62, 1024
    v_xor_b32 v31, 96, v30
    buffer_load_dwordx4 v31, s[44:47], s61 offen nt lds
    s_add_u32 s61, s61, 1024
    s_mov_b32 m0, s62
    s_add_u32 s62, s62, 1024
    v_xor_b32 v31, 0, v30
    buffer_load_dwordx4 v31, s[44:47], s61 offen nt lds
    s_add_u32 s61, s61, 1024
    s_mov_b32 m0, s62
    s_add_u32 s62, s62, 1024
    v_xor_b32 v31, 32, v30
    buffer_load_dwordx4 v31, s[44:47], s61 offen nt lds
    s_add_u32 s61, s61, 1024
    s_mov_b32 m0, s62
    s_add_u32 s62, s62, 1024
    v_xor_b32 v31, 64, v30
    buffer_load_dwordx4 v31, s[44:47], s61 offen nt lds
    s_add_u32 s61, s61, 1024
    s_mov_b32 m0, s62
    s_add_u32 s62, s62, 1024
    v_xor_b32 v31, 96, v30
    buffer_load_dwordx4 v31, s[44:47], s61 offen nt lds
    s_add_u32 s61, s61, 1024
    v_lshrrev_b32 v12, 2, v1
    v_mul_u32_u24 v12, 3584, v12
    v_and_b32 v13, 3, v1
    v_lshlrev_b32 v14, 1, v11
    v_xor_b32 v13, v13, v14
    v_xor_b32 v14, 1, v13
    v_lshl_add_u32 v14, v14, 4, v12
    v_lshl_add_u32 v12, v13, 4, v12
    s_mul_i32 s61, s52, 458752
    s_lshl_b32 s62, s67, 6
    s_add_u32 s61, s61, s62
    s_lshl_b32 s62, s52, 13
    s_add_u32 s62, s62, 0
    s_mov_b32 m0, s62
    s_add_u32 s62, s62, 1024
    buffer_load_dwordx4 v12, s[36:39], s61 offen  lds
    s_add_u32 s61, s61, 57344
    s_mov_b32 m0, s62
    s_add_u32 s62, s62, 1024
    buffer_load_dwordx4 v12, s[36:39], s61 offen  lds
    s_add_u32 s61, s61, 57344
    s_mov_b32 m0, s62
    s_add_u32 s62, s62, 1024
    buffer_load_dwordx4 v12, s[36:39], s61 offen  lds
    s_add_u32 s61, s61, 57344
    s_mov_b32 m0, s62
    s_add_u32 s62, s62, 1024
    buffer_load_dwordx4 v12, s[36:39], s61 offen  lds
    s_add_u32 s61, s61, 57344
    s_mov_b32 m0, s62
    s_add_u32 s62, s62, 1024
    buffer_load_dwordx4 v12, s[36:39], s61 offen  lds
    s_add_u32 s61, s61, 57344
    s_mov_b32 m0, s62
    s_add_u32 s62, s62, 1024
    buffer_load_dwordx4 v12, s[36:39], s61 offen  lds
    s_add_u32 s61, s61, 57344
    s_mov_b32 m0, s62
    s_add_u32 s62, s62, 1024
    buffer_load_dwordx4 v12, s[36:39], s61 offen  lds
    s_add_u32 s61, s61, 57344
    s_mov_b32 m0, s62
    s_add_u32 s62, s62, 1024
    buffer_load_dwordx4 v12, s[36:39], s61 offen  lds
    s_add_u32 s61, s61, 57344
    s_mul_i32 s61, s52, 458752
    s_lshl_b32 s62, s67, 6
    s_add_u32 s61, s61, s62
    s_lshl_b32 s62, s52, 13
    s_add_u32 s62, s62, 32768
    s_mov_b32 m0, s62
    s_add_u32 s62, s62, 1024
    buffer_load_dwordx4 v14, s[40:43], s61 offen  lds
    s_add_u32 s61, s61, 57344
    s_mov_b32 m0, s62
    s_add_u32 s62, s62, 1024
    buffer_load_dwordx4 v14, s[40:43], s61 offen  lds
    s_add_u32 s61, s61, 57344
    s_mov_b32 m0, s62
    s_add_u32 s62, s62, 1024
    buffer_load_dwordx4 v14, s[40:43], s61 offen  lds
    s_add_u32 s61, s61, 57344
    s_mov_b32 m0, s62
    s_add_u32 s62, s62, 1024
    buffer_load_dwordx4 v14, s[40:43], s61 offen  lds
    s_add_u32 s61, s61, 57344
    s_mov_b32 m0, s62
    s_add_u32 s62, s62, 1024
    buffer_load_dwordx4 v14, s[40:43], s61 offen  lds
    s_add_u32 s61, s61, 57344
    s_mov_b32 m0, s62
    s_add_u32 s62, s62, 1024
    buffer_load_dwordx4 v14, s[40:43], s61 offen  lds
    s_add_u32 s61, s61, 57344
    s_mov_b32 m0, s62
    s_add_u32 s62, s62, 1024
    buffer_load_dwordx4 v14, s[40:43], s61 offen  lds
    s_add_u32 s61, s61, 57344
    s_mov_b32 m0, s62
    s_add_u32 s62, s62, 1024
    buffer_load_dwordx4 v14, s[40:43], s61 offen  lds
    s_add_u32 s61, s61, 57344
    v_lshlrev_b32 v25, 3, v1
    s_lshl_b32 s61, s52, 10
    buffer_load_dwordx4 v[44:47], v8, s[48:51], s61 offen
    v_bfe_u32 v12, v1, 2, 2
    v_lshl_add_u32 v12, v2, 3, v12
    v_lshlrev_b32 v13, 6, v12
    v_and_b32 v14, 1, v1
    v_lshl_add_u32 v13, v14, 3, v13
    v_bfe_u32 v14, v1, 1, 1
    v_lshl_add_u32 v13, v14, 15, v13
    v_and_b32 v9, 1, v2
    v_lshl_add_u32 v14, v9, 1, v14
    v_xor_b32 v14, s52, v14
    v_lshl_add_u32 v13, v14, 4, v13
    v_bfe_u32 v14, v1, 2, 2
    v_lshl_add_u32 v14, v9, 2, v14
    v_lshlrev_b32 v12, 10, v12
    v_lshl_add_u32 v12, v14, 5, v12
    v_and_b32 v14, 3, v1
    v_lshl_add_u32 v12, v14, 3, v12
    s_lshl_b32 s61, s52, 8
    s_add_u32 s61, s61, 65536
    v_add_u32 v12, s61, v12
    s_mul_i32 s61, s52, 1088
    s_add_u32 s61, s61, 131072
    v_add_u32 v20, s61, v8
    v_and_b32 v14, 3, v3
    v_mul_u32_u24 v21, 1088, v14
    v_lshl_add_u32 v21, v2, 4, v21
    v_add_u32 v21, 131072, v21
    v_lshlrev_b32 v22, 6, v14
    v_lshl_add_u32 v23, v2, 4, v22
    v_add_u32 v23, 139264, v23
    v_lshl_add_u32 v22, v2, 3, v22
    s_lshl_b32 s61, s52, 4
    s_add_u32 s61, s61, 139264
    v_add_u32 v22, s61, v22
    v_lshlrev_b32 v24, 6, v3
    v_lshl_add_u32 v24, v2, 4, v24
    v_lshrrev_b32 v26, 1, v1
    v_lshlrev_b32 v26, 7, v26
    v_and_b32 v27, 1, v1
    v_lshl_add_u32 v26, v27, 4, v26
    v_lshrrev_b32 v25, 2, v1
    v_lshlrev_b32 v25, 8, v25
    v_and_b32 v27, 3, v1
    v_lshl_add_u32 v25, v27, 4, v25
    s_lshl_b32 s64, s52, 12
    s_add_u32 s64, s64, 458752
    s_add_u32 s65, s64, 1024
    s_add_u32 s66, s64, 2048
    buffer_load_dwordx4 v[48:51], v8, s[32:35], s64 offen sc1
    buffer_load_dwordx4 v[52:55], v8, s[32:35], s65 offen sc1
    buffer_load_dwordx4 v[56:59], v8, s[32:35], s66 offen sc1
    s_waitcnt vmcnt(0)
    s_barrier
    ds_read_b64_tr_b16 a[0:1], v13 offset:0
    ds_read_b64_tr_b16 a[2:3], v13 offset:256
    ds_read_b64_tr_b16 a[4:5], v13 offset:2048
    ds_read_b64_tr_b16 a[6:7], v13 offset:2304
    ds_read_b64_tr_b16 a[8:9], v13 offset:4096
    ds_read_b64_tr_b16 a[10:11], v13 offset:4352
    ds_read_b64_tr_b16 a[12:13], v13 offset:6144
    ds_read_b64_tr_b16 a[14:15], v13 offset:6400
    ds_read_b64_tr_b16 a[16:17], v13 offset:8192
    ds_read_b64_tr_b16 a[18:19], v13 offset:8448
    ds_read_b64_tr_b16 a[20:21], v13 offset:10240
    ds_read_b64_tr_b16 a[22:23], v13 offset:10496
    ds_read_b64_tr_b16 a[24:25], v13 offset:12288
    ds_read_b64_tr_b16 a[26:27], v13 offset:12544
    ds_read_b64_tr_b16 a[28:29], v13 offset:14336
    ds_read_b64_tr_b16 a[30:31], v13 offset:14592
    ds_read_b64_tr_b16 a[32:33], v13 offset:16384
    ds_read_b64_tr_b16 a[34:35], v13 offset:16640
    ds_read_b64_tr_b16 a[36:37], v13 offset:18432
    ds_read_b64_tr_b16 a[38:39], v13 offset:18688
    ds_read_b64_tr_b16 a[40:41], v13 offset:20480
    ds_read_b64_tr_b16 a[42:43], v13 offset:20736
    ds_read_b64_tr_b16 a[44:45], v13 offset:22528
    ds_read_b64_tr_b16 a[46:47], v13 offset:22784
    ds_read_b64_tr_b16 a[48:49], v13 offset:24576
    ds_read_b64_tr_b16 a[50:51], v13 offset:24832
    ds_read_b64_tr_b16 a[52:53], v13 offset:26624
    ds_read_b64_tr_b16 a[54:55], v13 offset:26880
    ds_read_b64_tr_b16 a[56:57], v13 offset:28672
    ds_read_b64_tr_b16 a[58:59], v13 offset:28928
    ds_read_b64_tr_b16 a[60:61], v13 offset:30720
    ds_read_b64_tr_b16 a[62:63], v13 offset:30976
    v_xor_b32 v32, 0, v12
    ds_read_b64_tr_b16 a[64:65], v32 offset:0
    ds_read_b64_tr_b16 a[66:67], v32 offset:4096
    v_xor_b32 v33, 32, v12
    ds_read_b64_tr_b16 a[68:69], v33 offset:0
    ds_read_b64_tr_b16 a[70:71], v33 offset:4096
    v_xor_b32 v34, 64, v12
    ds_read_b64_tr_b16 a[72:73], v34 offset:0
    ds_read_b64_tr_b16 a[74:75], v34 offset:4096
    v_xor_b32 v35, 96, v12
    ds_read_b64_tr_b16 a[76:77], v35 offset:0
    ds_read_b64_tr_b16 a[78:79], v35 offset:4096
    v_xor_b32 v36, 128, v12
    ds_read_b64_tr_b16 a[80:81], v36 offset:0
    ds_read_b64_tr_b16 a[82:83], v36 offset:4096
    v_xor_b32 v37, 160, v12
    ds_read_b64_tr_b16 a[84:85], v37 offset:0
    ds_read_b64_tr_b16 a[86:87], v37 offset:4096
    v_xor_b32 v38, 192, v12
    ds_read_b64_tr_b16 a[88:89], v38 offset:0
    ds_read_b64_tr_b16 a[90:91], v38 offset:4096
    v_xor_b32 v39, 224, v12
    ds_read_b64_tr_b16 a[92:93], v39 offset:0
    ds_read_b64_tr_b16 a[94:95], v39 offset:4096
    s_mov_b32 s63, 0
    s_branch Lpc_44
Lp_42:
    buffer_load_dwordx4 v[48:51], v8, s[32:35], s64 offen sc1
    buffer_load_dwordx4 v[52:55], v8, s[32:35], s65 offen sc1
    buffer_load_dwordx4 v[56:59], v8, s[32:35], s66 offen sc1
Lpc_44:
    s_waitcnt vmcnt(0)
    v_max3_u32 v15, v48, v49, v50
    v_max3_u32 v15, v15, v51, v52
    v_max3_u32 v15, v15, v53, v54
    v_max3_u32 v15, v15, v55, v56
    v_max3_u32 v15, v15, v57, v58
    v_max_u32 v15, v15, v59
    v_cmp_eq_u32 vcc, -1, v15
    s_cbranch_vccz Lpd_43
    s_add_u32 s63, s63, 1
    s_sleep 3
    s_cmp_lt_u32 s63, 30000
    s_cbranch_scc1 Lp_42
Lpd_43:
    v_lshlrev_b32 v160, 16, v44
    v_and_b32 v161, 0xffff0000, v44
    v_lshlrev_b32 v168, 16, v48
    v_and_b32 v169, 0xffff0000, v48
    v_lshlrev_b32 v176, 16, v52
    v_and_b32 v177, 0xffff0000, v52
    v_lshlrev_b32 v184, 16, v56
    v_and_b32 v185, 0xffff0000, v56
    v_lshlrev_b32 v162, 16, v45
    v_and_b32 v163, 0xffff0000, v45
    v_lshlrev_b32 v170, 16, v49
    v_and_b32 v171, 0xffff0000, v49
    v_lshlrev_b32 v178, 16, v53
    v_and_b32 v179, 0xffff0000, v53
    v_lshlrev_b32 v186, 16, v57
    v_and_b32 v187, 0xffff0000, v57
    v_lshlrev_b32 v164, 16, v46
    v_and_b32 v165, 0xffff0000, v46
    v_lshlrev_b32 v172, 16, v50
    v_and_b32 v173, 0xffff0000, v50
    v_lshlrev_b32 v180, 16, v54
    v_and_b32 v181, 0xffff0000, v54
    v_lshlrev_b32 v188, 16, v58
    v_and_b32 v189, 0xffff0000, v58
    v_lshlrev_b32 v166, 16, v47
    v_and_b32 v167, 0xffff0000, v47
    v_lshlrev_b32 v174, 16, v51
    v_and_b32 v175, 0xffff0000, v51
    v_lshlrev_b32 v182, 16, v55
    v_and_b32 v183, 0xffff0000, v55
    v_lshlrev_b32 v190, 16, v59
    v_and_b32 v191, 0xffff0000, v59
    v_add_f32 v184, 1.0, v184
    v_add_f32 v185, 1.0, v185
    v_add_f32 v186, 1.0, v186
    v_add_f32 v187, 1.0, v187
    v_add_f32 v188, 1.0, v188
    v_add_f32 v189, 1.0, v189
    v_add_f32 v190, 1.0, v190
    v_add_f32 v191, 1.0, v191
    s_lshl_b32 s61, s67, 13
    s_lshl_b32 s62, s52, 11
    s_add_u32 s65, s61, s62
    s_add_u32 s65, s65, 524288
    s_lshl_b32 s64, s52, 6
    s_add_u32 s64, s64, 425984
    s_mov_b32 s60, 0x3b000000
    s_mov_b32 s66, 0xbfb8aa3b
    s_add_u32 s58, s64, 8192
    v_mov_b32 v28, 0x00003f80
    v_mov_b32 v29, 0x3f800000
    s_or_b32 s71, s67, s52
    s_and_b32 s71, s71, 7
    s_lshl_b32 s70, s53, 7
    s_add_u32 s70, s70, 188416
    v_mov_b32 v43, s55
    v_lshlrev_b32 v27, 7, v1
    s_mov_b32 s62, 180224
    s_and_b32 exec_lo, s16, 0xff
    s_mov_b32 exec_hi, 0
    s_mov_b32 s63, 0
Lp_46:
    buffer_load_dword v15, v27, s[32:35], s62 offen sc1
Lpc_48:
    s_waitcnt vmcnt(0)
    v_cmp_ne_u32 vcc, s55, v15
    s_cbranch_vccz Lpd_47
    s_add_u32 s63, s63, 1
    s_cmp_lt_u32 s63, 30000
    s_cbranch_scc1 Lp_46
Lpd_47:
    s_mov_b64 exec, s[16:17]
    s_mov_b32 s63, 0
Lp_49:
    s_add_u32 s61, s64, 4096
    s_add_u32 s62, s58, 4096
    buffer_load_dwordx4 v[96:99], v25, s[32:35], s64 offen sc1
    buffer_load_dwordx4 v[100:103], v25, s[32:35], s61 offen sc1
    buffer_load_dwordx4 v[104:107], v25, s[32:35], s58 offen sc1
    buffer_load_dwordx4 v[108:111], v25, s[32:35], s62 offen sc1
Lpc_51:
    s_waitcnt vmcnt(0)
    v_max3_u32 v15, v96, v97, v98
    v_max3_u32 v15, v15, v99, v100
    v_max3_u32 v15, v15, v101, v102
    v_max3_u32 v15, v15, v103, v104
    v_max3_u32 v15, v15, v105, v106
    v_max3_u32 v15, v15, v107, v108
    v_max3_u32 v15, v15, v109, v110
    v_max_u32 v15, v15, v111
    v_cmp_eq_u32 vcc, -1, v15
    s_cbranch_vccz Lpd_50
    s_add_u32 s63, s63, 1
    s_cmp_lt_u32 s63, 30000
    s_cbranch_scc1 Lp_49
Lpd_50:
    v_lshlrev_b32 v64, 16, v96
    v_and_b32 v65, 0xffff0000, v96
    v_lshlrev_b32 v66, 16, v97
    v_and_b32 v67, 0xffff0000, v97
    v_lshlrev_b32 v68, 16, v98
    v_and_b32 v69, 0xffff0000, v98
    v_lshlrev_b32 v70, 16, v99
    v_and_b32 v71, 0xffff0000, v99
    v_dot2_f32_bf16 v64, v100, v28, v64
    v_dot2_f32_bf16 v65, v100, v29, v65
    v_dot2_f32_bf16 v66, v101, v28, v66
    v_dot2_f32_bf16 v67, v101, v29, v67
    v_dot2_f32_bf16 v68, v102, v28, v68
    v_dot2_f32_bf16 v69, v102, v29, v69
    v_dot2_f32_bf16 v70, v103, v28, v70
    v_dot2_f32_bf16 v71, v103, v29, v71
    v_dot2_f32_bf16 v64, v104, v28, v64
    v_dot2_f32_bf16 v65, v104, v29, v65
    v_dot2_f32_bf16 v66, v105, v28, v66
    v_dot2_f32_bf16 v67, v105, v29, v67
    v_dot2_f32_bf16 v68, v106, v28, v68
    v_dot2_f32_bf16 v69, v106, v29, v69
    v_dot2_f32_bf16 v70, v107, v28, v70
    v_dot2_f32_bf16 v71, v107, v29, v71
    v_dot2_f32_bf16 v64, v108, v28, v64
    v_dot2_f32_bf16 v65, v108, v29, v65
    v_dot2_f32_bf16 v66, v109, v28, v66
    v_dot2_f32_bf16 v67, v109, v29, v67
    v_dot2_f32_bf16 v68, v110, v28, v68
    v_dot2_f32_bf16 v69, v110, v29, v69
    v_dot2_f32_bf16 v70, v111, v28, v70
    v_dot2_f32_bf16 v71, v111, v29, v71
    s_nop 1
    v_pk_fma_f32 v[64:65], v[64:65], v[168:169], v[160:161]
    v_pk_fma_f32 v[66:67], v[66:67], v[170:171], v[162:163]
    v_pk_fma_f32 v[68:69], v[68:69], v[172:173], v[164:165]
    v_pk_fma_f32 v[70:71], v[70:71], v[174:175], v[166:167]
    v_readfirstlane_b32 s62, v64
    s_nop 1
    v_mov_b32 v30, s62
    v_mov_b32 v31, s62
    v_pk_add_f32 v[64:65], v[64:65], v[30:31] neg_lo:[0,1] neg_hi:[0,1]
    v_pk_add_f32 v[66:67], v[66:67], v[30:31] neg_lo:[0,1] neg_hi:[0,1]
    v_pk_add_f32 v[68:69], v[68:69], v[30:31] neg_lo:[0,1] neg_hi:[0,1]
    v_pk_add_f32 v[70:71], v[70:71], v[30:31] neg_lo:[0,1] neg_hi:[0,1]
    v_pk_add_f32 v[72:73], v[64:65], v[66:67]
    v_pk_mul_f32 v[74:75], v[64:65], v[64:65]
    v_pk_add_f32 v[80:81], v[68:69], v[70:71]
    v_pk_fma_f32 v[74:75], v[66:67], v[66:67], v[74:75]
    v_pk_add_f32 v[72:73], v[72:73], v[80:81]
    v_pk_fma_f32 v[74:75], v[68:69], v[68:69], v[74:75]
    v_pk_fma_f32 v[74:75], v[70:71], v[70:71], v[74:75]
    v_add_f32 v72, v72, v73
    v_add_f32 v73, v74, v75
    s_nop 0
    v_add_f32_dpp v72, v72, v72 row_ror:8 row_mask:0xf bank_mask:0xf
    v_add_f32_dpp v73, v73, v73 row_ror:8 row_mask:0xf bank_mask:0xf
    s_nop 0
    v_add_f32_dpp v72, v72, v72 row_ror:4 row_mask:0xf bank_mask:0xf
    v_add_f32_dpp v73, v73, v73 row_ror:4 row_mask:0xf bank_mask:0xf
    s_nop 0
    v_add_f32_dpp v72, v72, v72 row_ror:2 row_mask:0xf bank_mask:0xf
    v_add_f32_dpp v73, v73, v73 row_ror:2 row_mask:0xf bank_mask:0xf
    s_nop 0
    v_add_f32_dpp v72, v72, v72 row_ror:1 row_mask:0xf bank_mask:0xf
    v_add_f32_dpp v73, v73, v73 row_ror:1 row_mask:0xf bank_mask:0xf
    v_mov_b32 v74, v72
    v_mov_b32 v75, v73
    s_nop 0
    v_permlane16_swap_b32 v72, v74
    v_permlane16_swap_b32 v73, v75
    v_pk_add_f32 v[72:73], v[72:73], v[74:75]
    v_mov_b32 v74, v72
    v_mov_b32 v75, v73
    s_nop 0
    v_permlane32_swap_b32 v72, v74
    v_permlane32_swap_b32 v73, v75
    v_pk_add_f32 v[72:73], v[72:73], v[74:75]
    v_mul_f32 v72, s60, v72
    v_mov_b32 v75, 0x3727c5ac
    v_fmac_f32 v75, s60, v73
    v_mov_b32 v73, v72
    v_fma_f32 v75, -v72, v72, v75
    v_max_f32 v75, 0x3727c5ac, v75
    v_rsq_f32 v74, v75
    v_pk_add_f32 v[64:65], v[64:65], v[72:73] neg_lo:[0,1] neg_hi:[0,1]
    v_pk_add_f32 v[66:67], v[66:67], v[72:73] neg_lo:[0,1] neg_hi:[0,1]
    v_pk_add_f32 v[68:69], v[68:69], v[72:73] neg_lo:[0,1] neg_hi:[0,1]
    v_pk_add_f32 v[70:71], v[70:71], v[72:73] neg_lo:[0,1] neg_hi:[0,1]
    v_mov_b32 v75, v74
    v_pk_mul_f32 v[64:65], v[64:65], v[184:185]
    v_pk_mul_f32 v[66:67], v[66:67], v[186:187]
    v_pk_mul_f32 v[68:69], v[68:69], v[188:189]
    v_pk_mul_f32 v[70:71], v[70:71], v[190:191]
    v_pk_fma_f32 v[64:65], v[64:65], v[74:75], v[176:177]
    v_pk_fma_f32 v[66:67], v[66:67], v[74:75], v[178:179]
    v_pk_fma_f32 v[68:69], v[68:69], v[74:75], v[180:181]
    v_pk_fma_f32 v[70:71], v[70:71], v[74:75], v[182:183]
    v_cvt_pk_bf16_f32 v76, v64, v65
    v_cvt_pk_bf16_f32 v77, v66, v67
    v_cvt_pk_bf16_f32 v78, v68, v69
    v_cvt_pk_bf16_f32 v79, v70, v71
    ds_write_b128 v20, v[76:79]
    s_waitcnt lgkmcnt(0)
    s_barrier
    ds_read_b128 v[64:67], v21 offset:0
    ds_read_b128 v[68:71], v21 offset:64
    ds_read_b128 v[72:75], v21 offset:128
    ds_read_b128 v[76:79], v21 offset:192
    ds_read_b128 v[80:83], v21 offset:256
    ds_read_b128 v[84:87], v21 offset:320
    ds_read_b128 v[88:91], v21 offset:384
    ds_read_b128 v[92:95], v21 offset:448
    ds_read_b128 v[96:99], v21 offset:512
    ds_read_b128 v[100:103], v21 offset:576
    ds_read_b128 v[104:107], v21 offset:640
    ds_read_b128 v[108:111], v21 offset:704
    ds_read_b128 v[112:115], v21 offset:768
    ds_read_b128 v[116:119], v21 offset:832
    ds_read_b128 v[120:123], v21 offset:896
    ds_read_b128 v[124:127], v21 offset:960
    s_cmp_lg_u32 s71, 0
    s_cbranch_scc1 Lh6_52
    s_and_b32 exec_lo, s16, 0x1
    s_mov_b32 exec_hi, 0
    buffer_store_dword v43, v4, s[32:35], s70 offen sc1
    s_mov_b64 exec, s[16:17]
Lh6_52:
    s_waitcnt lgkmcnt(15)
    v_mfma_f32_16x16x32_bf16 v[44:47], a[0:3], v[64:67], 0
    s_waitcnt lgkmcnt(14)
    v_mfma_f32_16x16x32_bf16 v[44:47], a[4:7], v[68:71], v[44:47]
    s_waitcnt lgkmcnt(13)
    v_mfma_f32_16x16x32_bf16 v[44:47], a[8:11], v[72:75], v[44:47]
    s_waitcnt lgkmcnt(12)
    v_mfma_f32_16x16x32_bf16 v[44:47], a[12:15], v[76:79], v[44:47]
    s_waitcnt lgkmcnt(11)
    v_mfma_f32_16x16x32_bf16 v[44:47], a[16:19], v[80:83], v[44:47]
    s_waitcnt lgkmcnt(10)
    v_mfma_f32_16x16x32_bf16 v[44:47], a[20:23], v[84:87], v[44:47]
    s_waitcnt lgkmcnt(9)
    v_mfma_f32_16x16x32_bf16 v[44:47], a[24:27], v[88:91], v[44:47]
    s_waitcnt lgkmcnt(8)
    v_mfma_f32_16x16x32_bf16 v[44:47], a[28:31], v[92:95], v[44:47]
    s_waitcnt lgkmcnt(7)
    v_mfma_f32_16x16x32_bf16 v[44:47], a[32:35], v[96:99], v[44:47]
    s_waitcnt lgkmcnt(6)
    v_mfma_f32_16x16x32_bf16 v[44:47], a[36:39], v[100:103], v[44:47]
    s_waitcnt lgkmcnt(5)
    v_mfma_f32_16x16x32_bf16 v[44:47], a[40:43], v[104:107], v[44:47]
    s_waitcnt lgkmcnt(4)
    v_mfma_f32_16x16x32_bf16 v[44:47], a[44:47], v[108:111], v[44:47]
    s_waitcnt lgkmcnt(3)
    v_mfma_f32_16x16x32_bf16 v[44:47], a[48:51], v[112:115], v[44:47]
    s_waitcnt lgkmcnt(2)
    v_mfma_f32_16x16x32_bf16 v[44:47], a[52:55], v[116:119], v[44:47]
    s_waitcnt lgkmcnt(1)
    v_mfma_f32_16x16x32_bf16 v[44:47], a[56:59], v[120:123], v[44:47]
    s_waitcnt lgkmcnt(0)
    v_mfma_f32_16x16x32_bf16 v[44:47], a[60:63], v[124:127], v[44:47]
    s_nop 7
    v_mul_f32 v48, s66, v44
    v_mul_f32 v49, s66, v45
    v_mul_f32 v50, s66, v46
    v_mul_f32 v51, s66, v47
    v_exp_f32 v48, v48
    v_exp_f32 v49, v49
    v_exp_f32 v50, v50
    v_exp_f32 v51, v51
    v_permlane32_swap_b32 v44, v52
    v_permlane32_swap_b32 v45, v53
    v_permlane32_swap_b32 v46, v54
    v_permlane32_swap_b32 v47, v55
    v_add_f32 v48, 1.0, v48
    v_add_f32 v49, 1.0, v49
    v_add_f32 v50, 1.0, v50
    v_add_f32 v51, 1.0, v51
    v_rcp_f32 v48, v48
    v_rcp_f32 v49, v49
    v_rcp_f32 v50, v50
    v_rcp_f32 v51, v51
    v_pk_mul_f32 v[48:49], v[48:49], v[52:53]
    v_pk_mul_f32 v[50:51], v[50:51], v[54:55]
    v_cvt_pk_bf16_f32 v44, v48, v49
    v_cvt_pk_bf16_f32 v45, v50, v51
    s_and_b32 exec_lo, s16, 0xf000f
    s_mov_b32 exec_hi, 0
    ds_write_b64 v22, v[44:45]
    s_mov_b64 exec, s[16:17]
    s_waitcnt lgkmcnt(0)
    s_barrier
    ds_read_b128 v[48:51], v23
    s_waitcnt lgkmcnt(0)
    v_mfma_f32_16x16x32_bf16 v[64:67], a[64:67], v[48:51], 0
    v_mfma_f32_16x16x32_bf16 v[68:71], a[68:71], v[48:51], 0
    v_mfma_f32_16x16x32_bf16 v[72:75], a[72:75], v[48:51], 0
    v_mfma_f32_16x16x32_bf16 v[76:79], a[76:79], v[48:51], 0
    v_mfma_f32_16x16x32_bf16 v[80:83], a[80:83], v[48:51], 0
    v_mfma_f32_16x16x32_bf16 v[84:87], a[84:87], v[48:51], 0
    v_mfma_f32_16x16x32_bf16 v[88:91], a[88:91], v[48:51], 0
    v_mfma_f32_16x16x32_bf16 v[92:95], a[92:95], v[48:51], 0
    s_and_b32 exec_lo, s16, 0xf000f
    s_and_b32 exec_hi, s16, 0xf000f
    buffer_store_dwordx4 v[64:67], v24, s[32:35], s65 offen offset:0 sc1
    buffer_store_dwordx4 v[68:71], v24, s[32:35], s65 offen offset:256 sc1
    buffer_store_dwordx4 v[72:75], v24, s[32:35], s65 offen offset:512 sc1
    buffer_store_dwordx4 v[76:79], v24, s[32:35], s65 offen offset:768 sc1
    buffer_store_dwordx4 v[80:83], v24, s[32:35], s65 offen offset:1024 sc1
    buffer_store_dwordx4 v[84:87], v24, s[32:35], s65 offen offset:1280 sc1
    buffer_store_dwordx4 v[88:91], v24, s[32:35], s65 offen offset:1536 sc1
    buffer_store_dwordx4 v[92:95], v24, s[32:35], s65 offen offset:1792 sc1
    s_mov_b64 exec, s[16:17]
L_fin:
L_end:
    s_endpgm
L_codeend:
.section .rodata,"a"
.p2align 6
.amdhsa_kernel adaLN_cond__compressed_kv_cla__glu_gated_glu__decode_kernel
  .amdhsa_next_free_vgpr 512
  .amdhsa_next_free_sgpr 102
  .amdhsa_accum_offset 256
  .amdhsa_group_segment_fixed_size 0
  .amdhsa_kernarg_size 120
  .amdhsa_user_sgpr_count 2
  .amdhsa_user_sgpr_kernarg_segment_ptr 1
  .amdhsa_system_sgpr_workgroup_id_x 1
.end_amdhsa_kernel
```
